```python
import torch

def _softmax(x, axis=-1):
    return torch.softmax(x, dim=axis)
def _gelu(x):
    return torch.nn.functional.gelu(x, approximate="tanh")
def _silu(x):
    return torch.nn.functional.silu(x)
def _sigmoid(x):
    return torch.sigmoid(x)
def _layernorm(x, axis=-1, eps=1e-5):
    m = x.mean(dim=axis, keepdim=True)
    v = x.var(dim=axis, keepdim=True, unbiased=False)
    return (x - m) / torch.sqrt(v + eps)
def _scatter_add(tgt, idx, src, axis=0):
    return tgt.clone().index_add_(axis, idx, src)
def _segment_sum(src, seg, n):
    out = torch.zeros((n,) + src.shape[1:], dtype=src.dtype)
    return out.index_add_(0, seg, src)
def _pad(x, pw):
    flat = tuple(v for pair in reversed(pw) for v in pair)
    return torch.nn.functional.pad(x, flat)

kernel_name = 'concat_heads__gqa_block_cached__gqa_block_cached__near_ridge'

def setup_inputs():

    _w = (lambda a: (lambda t: t.to(torch.bfloat16) if t.is_floating_point() else t)(torch.as_tensor(a)))
    def _A_setup():
        B, Sq, D = 8, 80, 512
        Hq, Hkv, Sk, Dh = 32, 8, 512, 128
        assert Hq % Hkv == 0, (Hq, Hkv)
        return {
            "x": _w((lambda *s: torch.randn(*s, dtype=torch.bfloat16) * 0.8)(B, Sq, D)),
            "k_cache": _w((lambda *s: torch.randn(*s, dtype=torch.bfloat16) * 0.8)(B, Hkv, Sk, Dh)),
            "v_cache": _w((lambda *s: torch.randn(*s, dtype=torch.bfloat16) * 0.05)(B, Hkv, Sk, Dh)),
            "wq": _w((lambda *s: torch.randn(*s, dtype=torch.bfloat16) * 0.8)(D, Hq * Dh) * (D ** -0.5)),
            "wo": _w((lambda *s: torch.randn(*s, dtype=torch.bfloat16) * 0.05)(Hq * Dh, D) * ((Hq * Dh) ** -0.5)),
        }
    _A_in = _A_setup()

    def _B_setup():
        B, Sq, D = 8, 80, 512
        Hq, Hkv, Sk, Dh = 32, 8, 512, 128
        assert Hq % Hkv == 0, (Hq, Hkv)
        return {
            "x": _w((lambda *s: torch.randn(*s, dtype=torch.bfloat16) * 0.8)(B, Sq, D)),
            "k_cache": _w((lambda *s: torch.randn(*s, dtype=torch.bfloat16) * 0.8)(B, Hkv, Sk, Dh)),
            "v_cache": _w((lambda *s: torch.randn(*s, dtype=torch.bfloat16) * 0.05)(B, Hkv, Sk, Dh)),
            "wq": _w((lambda *s: torch.randn(*s, dtype=torch.bfloat16) * 0.8)(D, Hq * Dh) * (D ** -0.5)),
            "wo": _w((lambda *s: torch.randn(*s, dtype=torch.bfloat16) * 0.05)(Hq * Dh, D) * ((Hq * Dh) ** -0.5)),
        }
    _B_in = _B_setup()

    return {
        "A_x": _A_in["x"],
        "A_k_cache": _A_in["k_cache"],
        "A_v_cache": _A_in["v_cache"],
        "A_wq": _A_in["wq"],
        "A_wo": _A_in["wo"],
        "B_x": _B_in["x"],
        "B_k_cache": _B_in["k_cache"],
        "B_v_cache": _B_in["v_cache"],
        "B_wq": _B_in["wq"],
        "B_wo": _B_in["wo"],
    }

def reference(A_x, A_k_cache, A_v_cache, A_wq, A_wo, B_x, B_k_cache, B_v_cache, B_wq, B_wo):
    def _A_ref(x, k_cache, v_cache, wq, wo):
        B, Sq, D = x.shape
        Hq, Dh = 32, 128
        Hkv = k_cache.shape[1]
        rep = Hq // Hkv
        q = (lambda x, *d: x.permute(*d))((x @ wq).reshape(B, Sq, Hq, Dh), 0, 2, 1, 3)
        k = (lambda x, n, axis: torch.repeat_interleave(x, n, dim=axis))(k_cache, rep, axis=1)
        v = (lambda x, n, axis: torch.repeat_interleave(x, n, dim=axis))(v_cache, rep, axis=1)
        scores = torch.einsum("bhqd,bhkd->bhqk", q, k) * (Dh ** -0.5)
        p = _softmax(scores, axis=-1)
        o = torch.einsum("bhqk,bhkd->bhqd", p, v)
        return (lambda x, *d: x.permute(*d))(o, 0, 2, 1, 3).reshape(B, Sq, Hq * Dh) @ wo

    def _B_ref(x, k_cache, v_cache, wq, wo):
        B, Sq, D = x.shape
        Hq, Dh = 32, 128
        Hkv = k_cache.shape[1]
        rep = Hq // Hkv
        q = (lambda x, *d: x.permute(*d))((x @ wq).reshape(B, Sq, Hq, Dh), 0, 2, 1, 3)
        k = (lambda x, n, axis: torch.repeat_interleave(x, n, dim=axis))(k_cache, rep, axis=1)
        v = (lambda x, n, axis: torch.repeat_interleave(x, n, dim=axis))(v_cache, rep, axis=1)
        scores = torch.einsum("bhqd,bhkd->bhqk", q, k) * (Dh ** -0.5)
        p = _softmax(scores, axis=-1)
        o = torch.einsum("bhqk,bhkd->bhqd", p, v)
        return (lambda x, *d: x.permute(*d))(o, 0, 2, 1, 3).reshape(B, Sq, Hq * Dh) @ wo

    a = _A_ref(A_x, A_k_cache, A_v_cache, A_wq, A_wo)
    b = _B_ref(B_x, B_k_cache, B_v_cache, B_wq, B_wo)
    return torch.concatenate([a, b], axis=-1)
```

```asm
; @launch grid=(256,1,1) block=(256,1,1) lds=163840
.amdgcn_target "amdgcn-amd-amdhsa--gfx950"
.text
.globl concat_heads__gqa_block_cached__gqa_block_cached__near_ridge_kernel
.p2align 8
.type concat_heads__gqa_block_cached__gqa_block_cached__near_ridge_kernel,@function
concat_heads__gqa_block_cached__gqa_block_cached__near_ridge_kernel:
    s_cmp_ge_u32 s2, 0x100
    s_cbranch_scc1 L_end
    s_bfe_u32 s61, s2, 65538
    s_mul_i32 s72, s61, 40
    s_load_dwordx2 s[4:5], s[0:1], s72 offset:0
    s_load_dwordx2 s[8:9], s[0:1], s72 offset:24
    v_lshrrev_b32 v2, 6, v0
    v_and_b32 v255, 63, v0
    s_mov_b32 s79, 0
    v_readfirstlane_b32 s60, v2
L_restart:
    s_lshr_b32 s62, s2, 5
    s_bfe_u32 s80, s2, 131075
    s_add_u32 s64, s80, s62
    s_lshl_b32 s64, s64, 2
    s_lshr_b32 s64, 0x43333, s64
    s_and_b32 s64, s64, 7
    v_lshrrev_b32 v5, 4, v255
    s_and_b32 s75, s60, 1
    s_lshl_b32 s65, s75, 3
    v_lshl_add_u32 v6, v5, 1, s65
    v_and_b32 v7, 15, v255
    v_xor_b32 v6, v6, v7
    v_lshlrev_b32 v6, 4, v6
    v_lshl_add_u32 v199, v5, 10, v6
    s_mov_b32 s6, 655360
    s_mov_b32 s7, 131072
    s_mul_i32 s65, s62, 20
    s_add_u32 s65, s65, s60
    s_lshl_b32 s65, s65, 12
    s_lshl_b32 s36, s64, 7
    s_add_u32 s36, s36, s65
    s_lshl_b32 s69, s60, 10
    s_mov_b32 m0, s69
    s_mov_b32 s68, s36
    s_waitcnt lgkmcnt(0)
    buffer_load_dwordx4 v199, s[4:7], s68 offen offset:0 lds
    s_addk_i32 m0, 0x1000
    s_addk_i32 s68, 0x4000
    buffer_load_dwordx4 v199, s[4:7], s68 offen offset:0 lds
    s_addk_i32 m0, 0x1000
    s_addk_i32 s68, 0x4000
    buffer_load_dwordx4 v199, s[4:7], s68 offen offset:0 lds
    s_addk_i32 m0, 0x1000
    s_addk_i32 s68, 0x4000
    buffer_load_dwordx4 v199, s[4:7], s68 offen offset:0 lds
    s_addk_i32 m0, 0x1000
    s_addk_i32 s68, 0x4000
    buffer_load_dwordx4 v199, s[4:7], s68 offen offset:0 lds
    s_and_b32 s63, s2, 3
    s_lshl_b32 s63, s63, 2
    s_add_u32 s63, s63, s80
    v_lshrrev_b32 v5, 3, v255
    v_and_b32 v6, 2, v5
    v_and_b32 v7, 7, v255
    v_xor_b32 v6, v6, v7
    v_lshlrev_b32 v6, 4, v6
    v_lshl_add_u32 v92, v5, 13, v6
    v_xor_b32 v6, 64, v92
    v_add_u32 v93, 64512, v6
    v_add_u32 v94, 129024, v92
    v_add_u32 v95, 193536, v6
    s_mov_b32 s10, 4194304
    s_mov_b32 s11, 131072
    s_lshl_b32 s66, s63, 2
    s_add_u32 s66, s66, s60
    s_lshl_b32 s66, s66, 7
    s_lshl_b32 s32, s64, 19
    s_add_u32 s32, s32, s66
    s_lshl_b32 s71, s60, 14
    s_add_u32 s71, s71, 98304
    s_add_u32 m0, s71, 0
    s_add_u32 s70, s32, 0
    buffer_load_dwordx4 v92, s[8:11], s70 offen offset:0 lds
    buffer_load_dwordx4 v93, s[8:11], s70 offen offset:1024 lds
    buffer_load_dwordx4 v94, s[8:11], s70 offen offset:2048 lds
    buffer_load_dwordx4 v95, s[8:11], s70 offen offset:3072 lds
    s_add_u32 m0, s71, 4096
    s_add_u32 s70, s32, 262144
    buffer_load_dwordx4 v92, s[8:11], s70 offen offset:0 lds
    buffer_load_dwordx4 v93, s[8:11], s70 offen offset:1024 lds
    buffer_load_dwordx4 v94, s[8:11], s70 offen offset:2048 lds
    buffer_load_dwordx4 v95, s[8:11], s70 offen offset:3072 lds
    s_getpc_b64 s[52:53]
L_pc:
    s_bfe_u32 s67, s2, 327683
    s_lshl_b32 s67, s67, 2
    s_add_u32 s67, s67, s60
    s_mul_i32 s67, s67, 384
    v_and_b32 v4, 3, v255
    v_lshl_add_u32 v3, v4, 7, s67
    v_min_u32 v3, L_codeend-L_pc-4, v3
    global_load_dword v230, v3, s[52:53]
    s_cmp_lg_u32 s79, 0
    s_cbranch_scc1 L_ptrs_skip
    s_load_dwordx4 s[40:43], s[0:1], s72 offset:8
    s_load_dwordx2 s[20:21], s[0:1], s72 offset:32
    s_load_dwordx4 s[44:47], s[0:1], 80
    s_load_dwordx2 s[24:25], s[0:1], 96
    s_memrealtime s[56:57]
L_ptrs_skip:
    s_mov_b32 s37, s65
    s_mov_b32 s33, s66
    s_lshl_b32 s34, s64, 19
    s_lshl_b32 s67, s64, 7
    v_and_b32 v109, 3072, v199
    v_add_u32 v110, s67, v199
    v_add_u32 v111, 256, v110
    v_and_b32 v111, 1023, v111
    v_or_b32 v192, v111, v109
    v_add_u32 v111, 512, v110
    v_and_b32 v111, 1023, v111
    v_or_b32 v193, v111, v109
    v_add_u32 v111, 768, v110
    v_and_b32 v111, 1023, v111
    v_or_b32 v194, v111, v109
    v_lshlrev_b32 v254, 4, v255
    s_cmp_lg_u32 s79, 0
    s_cbranch_scc1 L_ptrs_done
    v_mov_b32 v200, 0
    v_mov_b32 v201, 0
    v_mov_b32 v202, 0
    v_mov_b32 v203, 0
    v_mov_b32 v204, 0
    v_mov_b32 v205, 0
    v_mov_b32 v206, 0
    v_mov_b32 v207, 0
    v_mov_b32 v208, 0
    v_mov_b32 v209, 0
    v_mov_b32 v210, 0
    v_mov_b32 v211, 0
    s_waitcnt lgkmcnt(0)
    s_mov_b64 s[12:13], s[40:41]
    s_mov_b64 s[16:17], s[42:43]
    s_mov_b64 s[28:29], s[44:45]
    s_mov_b64 s[48:49], s[46:47]
L_ptrs_done:
    s_mov_b32 s14, 8388608
    s_mov_b32 s15, 131072
    s_mov_b32 s18, 8388608
    s_mov_b32 s19, 131072
    s_mov_b32 s22, 4194304
    s_mov_b32 s23, 131072
    s_mov_b32 s26, 268435456
    s_mov_b32 s27, 131072
    s_mov_b32 s30, 1310720
    s_mov_b32 s31, 131072
    s_mov_b32 s50, 256
    s_mov_b32 s51, 131072
    v_and_b32 v102, 15, v255
    v_lshrrev_b32 v103, 4, v255
    v_and_b32 v101, 3, v255
    v_bfe_u32 v98, v255, 3, 2
    v_bfe_u32 v99, v255, 2, 2
    v_lshl_add_u32 v99, v103, 3, v99
    v_lshlrev_b32 v99, 7, v99
    v_lshl_add_u32 v99, v101, 3, v99
    v_add_u32 v99, s71, v99
    v_xor_b32 v100, 0, v98
    v_lshl_add_u32 v88, v100, 5, v99
    v_xor_b32 v100, 1, v98
    v_lshl_add_u32 v89, v100, 5, v99
    v_xor_b32 v100, 2, v98
    v_lshl_add_u32 v90, v100, 5, v99
    v_xor_b32 v100, 3, v98
    v_lshl_add_u32 v91, v100, 5, v99
    v_and_b32 v98, 7, v255
    v_lshlrev_b32 v98, 1, v98
    v_xor_b32 v98, v98, v103
    v_xor_b32 v99, 0, v98
    v_lshlrev_b32 v99, 4, v99
    v_lshl_add_u32 v80, v102, 8, v99
    v_add_u32 v84, 77824, v80
    v_xor_b32 v99, 4, v98
    v_lshlrev_b32 v99, 4, v99
    v_lshl_add_u32 v81, v102, 8, v99
    v_add_u32 v85, 77824, v81
    v_xor_b32 v99, 8, v98
    v_lshlrev_b32 v99, 4, v99
    v_lshl_add_u32 v82, v102, 8, v99
    v_add_u32 v86, 77824, v82
    v_xor_b32 v99, 12, v98
    v_lshlrev_b32 v99, 4, v99
    v_lshl_add_u32 v83, v102, 8, v99
    v_add_u32 v87, 77824, v83
    s_add_u32 m0, s71, 8192
    s_add_u32 s70, s32, 524288
    buffer_load_dwordx4 v92, s[8:11], s70 offen offset:0 lds
    buffer_load_dwordx4 v93, s[8:11], s70 offen offset:1024 lds
    buffer_load_dwordx4 v94, s[8:11], s70 offen offset:2048 lds
    buffer_load_dwordx4 v95, s[8:11], s70 offen offset:3072 lds
    s_lshl_b32 s42, s61, 3
    s_add_u32 s42, s42, s62
    s_add_u32 s41, s62, s80
    s_and_b32 s41, s41, 3
    s_lshl_b32 s41, s41, 2
    s_lshr_b32 s65, s63, 2
    s_add_u32 s41, s41, s65
    s_and_b32 s65, s79, 1
    s_or_b32 s65, s65, s41
    s_or_b32 s65, s65, s60
    s_lshl_b32 s65, s65, 8
    s_lshl_b32 s66, s42, 2
    s_add_u32 s65, s65, s66
    v_lshl_add_u32 v190, v255, 8, s65
    s_or_b32 s67, s56, 1
    v_mov_b32 v191, s67
    v_add_u32 v250, 0, v254
    v_add_u32 v251, 3040, v254
    v_add_u32 v252, 6080, v254
    v_add_u32 v253, 9120, v254
    v_lshrrev_b32 v98, 3, v255
    v_and_b32 v99, 6, v98
    v_and_b32 v100, 7, v255
    v_xor_b32 v99, v99, v100
    v_lshlrev_b32 v99, 4, v99
    v_lshl_add_u32 v246, v98, 10, v99
    v_add_u32 v247, 7168, v246
    v_add_u32 v248, 14336, v246
    v_add_u32 v249, 21504, v246
    v_mul_u32_u24 v98, 1056, v102
    v_lshl_add_u32 v98, v103, 4, v98
    v_lshrrev_b32 v99, 2, v255
    v_mul_u32_u24 v100, 1056, v99
    v_and_b32 v101, 3, v255
    v_lshl_add_u32 v100, v101, 3, v100
    s_xor_b32 s65, s75, 0
    s_lshl_b32 s65, s65, 9
    v_add_u32 v244, s65, v98
    s_xor_b32 s66, s75, 0
    s_lshl_b32 s66, s66, 7
    s_add_u32 m0, s71, 12288
    s_add_u32 s70, s32, 786432
    buffer_load_dwordx4 v92, s[8:11], s70 offen offset:0 lds
    buffer_load_dwordx4 v93, s[8:11], s70 offen offset:1024 lds
    buffer_load_dwordx4 v94, s[8:11], s70 offen offset:2048 lds
    buffer_load_dwordx4 v95, s[8:11], s70 offen offset:3072 lds
    s_add_u32 m0, s69, 20480
    s_add_u32 s68, s37, 0
    s_add_u32 s70, s34, 1048576
    s_and_b32 s70, s70, 4194303
    s_add_u32 s70, s70, s33
    s_waitcnt vmcnt(13)
    s_barrier
    ds_read_b64_tr_b16 a[0:1], v88 offset:0
    ds_read_b64_tr_b16 a[2:3], v88 offset:512
    ds_read_b128 a[80:83], v80 offset:0
    ds_read_b64_tr_b16 a[4:5], v89 offset:0
    ds_read_b64_tr_b16 a[6:7], v89 offset:512
    ds_read_b64_tr_b16 a[8:9], v90 offset:0
    ds_read_b64_tr_b16 a[10:11], v90 offset:512
    ds_read_b64_tr_b16 a[12:13], v91 offset:0
    ds_read_b64_tr_b16 a[14:15], v91 offset:512
    ds_read_b128 a[84:87], v80 offset:4096
    ds_read_b128 a[88:91], v80 offset:8192
    ds_read_b128 a[92:95], v80 offset:12288
    ds_read_b128 a[96:99], v80 offset:16384
    ds_read_b128 a[100:103], v81 offset:0
    ds_read_b128 a[104:107], v81 offset:4096
    ds_read_b128 a[108:111], v81 offset:8192
    ds_read_b128 a[112:115], v81 offset:12288
    ds_read_b128 a[116:119], v81 offset:16384
    ds_read_b128 a[120:123], v82 offset:0
    ds_read_b128 a[124:127], v83 offset:0
    s_waitcnt lgkmcnt(14)
    v_mfma_f32_16x16x32_bf16 v[0:3], a[0:3], a[80:83], 0
    s_add_u32 s66, s66, s65
    v_lshlrev_b32 v99, 7, v99
    v_mov_b32 v224, 0x3f803f80
    v_mfma_f32_16x16x32_bf16 v[20:23], a[4:7], a[80:83], 0
    s_waitcnt lgkmcnt(13)
    v_lshl_add_u32 v99, v101, 3, v99
    v_mov_b32 v225, 0x3f803f80
    v_mfma_f32_16x16x32_bf16 v[40:43], a[8:11], a[80:83], 0
    s_waitcnt lgkmcnt(11)
    v_mov_b32 v226, 0x3f803f80
    v_mov_b32 v227, 0x3f803f80
    v_mfma_f32_16x16x32_bf16 v[60:63], a[12:15], a[80:83], 0
    s_waitcnt lgkmcnt(10)
    s_add_u32 s66, s66, 50688
    v_add_u32 v240, s66, v100
    v_mfma_f32_16x16x32_bf16 v[64:67], a[12:15], a[84:87], 0
    s_xor_b32 s66, s75, 1
    s_lshl_b32 s66, s66, 7
    v_mfma_f32_16x16x32_bf16 v[44:47], a[8:11], a[84:87], 0
    s_waitcnt vmcnt(9)
    s_add_u32 s66, s66, s65
    s_add_u32 s66, s66, 50688
    v_mfma_f32_16x16x32_bf16 v[24:27], a[4:7], a[84:87], 0
    s_xor_b32 s65, s75, 1
    v_add_u32 v241, s66, v100
    v_mfma_f32_16x16x32_bf16 v[4:7], a[0:3], a[84:87], 0
    s_waitcnt lgkmcnt(6)
    ds_read_b64_tr_b16 a[16:17], v88 offset:4096
    ds_read_b64_tr_b16 a[18:19], v88 offset:4608
    v_mfma_f32_16x16x32_bf16 v[8:11], a[0:3], a[88:91], 0
    s_lshl_b32 s65, s65, 9
    ds_read_b64_tr_b16 a[20:21], v89 offset:4096
    ds_read_b64_tr_b16 a[22:23], v89 offset:4608
    v_mfma_f32_16x16x32_bf16 v[28:31], a[4:7], a[88:91], 0
    s_xor_b32 s66, s75, 0
    ds_read_b64_tr_b16 a[24:25], v90 offset:4096
    ds_read_b64_tr_b16 a[26:27], v90 offset:4608
    v_mfma_f32_16x16x32_bf16 v[48:51], a[8:11], a[88:91], 0
    buffer_load_dwordx4 v192, s[4:7], s68 offen offset:0 lds
    v_mfma_f32_16x16x32_bf16 v[68:71], a[12:15], a[88:91], 0
    s_add_u32 m0, s69, 24576
    ds_read_b64_tr_b16 a[28:29], v91 offset:4096
    ds_read_b64_tr_b16 a[30:31], v91 offset:4608
    v_mfma_f32_16x16x32_bf16 v[72:75], a[12:15], a[92:95], 0
    s_add_u32 s68, s37, 16384
    ds_read_b128 a[80:83], v82 offset:4096
    ds_read_b128 a[84:87], v83 offset:4096
    v_mfma_f32_16x16x32_bf16 v[52:55], a[8:11], a[92:95], 0
    buffer_load_dwordx4 v192, s[4:7], s68 offen offset:0 lds
    v_mfma_f32_16x16x32_bf16 v[32:35], a[4:7], a[92:95], 0
    s_add_u32 m0, s69, 28672
    ds_read_b128 a[88:91], v82 offset:8192
    v_add_u32 v245, s65, v98
    v_mfma_f32_16x16x32_bf16 v[12:15], a[0:3], a[92:95], 0
    s_add_u32 s68, s37, 32768
    ds_read_b128 a[92:95], v83 offset:8192
    v_bfe_u32 v98, v255, 3, 2
    v_mfma_f32_16x16x32_bf16 v[16:19], a[0:3], a[96:99], 0
    buffer_load_dwordx4 v192, s[4:7], s68 offen offset:0 lds
    v_mfma_f32_16x16x32_bf16 v[36:39], a[4:7], a[96:99], 0
    s_add_u32 m0, s69, 32768
    s_add_u32 s68, s37, 49152
    s_lshl_b32 s66, s66, 7
    v_mfma_f32_16x16x32_bf16 v[56:59], a[8:11], a[96:99], 0
    s_waitcnt lgkmcnt(4)
    s_add_u32 s66, s66, s65
    s_add_u32 s66, s66, 50688
    v_mfma_f32_16x16x32_bf16 v[76:79], a[12:15], a[96:99], 0
    buffer_load_dwordx4 v192, s[4:7], s68 offen offset:0 lds
    v_mfma_f32_16x16x32_bf16 v[0:3], a[16:19], a[100:103], v[0:3]
    s_add_u32 m0, s69, 36864
    ds_read_b128 a[96:99], v82 offset:12288
    v_add_u32 v242, s66, v100
    v_mfma_f32_16x16x32_bf16 v[20:23], a[20:23], a[100:103], v[20:23]
    s_add_u32 s68, s37, 65536
    s_xor_b32 s66, s75, 1
    s_lshl_b32 s66, s66, 7
    v_mfma_f32_16x16x32_bf16 v[40:43], a[24:27], a[100:103], v[40:43]
    buffer_load_dwordx4 v192, s[4:7], s68 offen offset:0 lds
    v_mfma_f32_16x16x32_bf16 v[60:63], a[28:31], a[100:103], v[60:63]
    s_add_u32 m0, s71, 0
    ds_read_b128 a[100:103], v83 offset:12288
    v_mfma_f32_16x16x32_bf16 v[64:67], a[28:31], a[104:107], v[64:67]
    s_add_u32 s68, s37, 0
    s_add_u32 s66, s66, s65
    s_add_u32 s66, s66, 50688
    v_mfma_f32_16x16x32_bf16 v[44:47], a[24:27], a[104:107], v[44:47]
    buffer_load_dwordx4 v92, s[8:11], s70 offen offset:0 lds
    v_mfma_f32_16x16x32_bf16 v[24:27], a[20:23], a[104:107], v[24:27]
    s_waitcnt vmcnt(10)
    ds_read_b64_tr_b16 a[32:33], v88 offset:8192
    ds_read_b64_tr_b16 a[34:35], v88 offset:8704
    v_mfma_f32_16x16x32_bf16 v[4:7], a[16:19], a[104:107], v[4:7]
    s_waitcnt vmcnt(6)
    ds_read_b64_tr_b16 a[48:49], v88 offset:12288
    ds_read_b64_tr_b16 a[50:51], v88 offset:12800
    v_mfma_f32_16x16x32_bf16 v[8:11], a[16:19], a[108:111], v[8:11]
    buffer_load_dwordx4 v93, s[8:11], s70 offen offset:1024 lds
    v_mfma_f32_16x16x32_bf16 v[28:31], a[20:23], a[108:111], v[28:31]
    s_lshl_b32 s65, s60, 12
    ds_read_b64_tr_b16 a[52:53], v89 offset:12288
    ds_read_b64_tr_b16 a[54:55], v89 offset:12800
    v_mfma_f32_16x16x32_bf16 v[48:51], a[24:27], a[108:111], v[48:51]
    s_add_u32 s65, s65, 118272
    ds_read_b64_tr_b16 a[36:37], v89 offset:8192
    ds_read_b64_tr_b16 a[38:39], v89 offset:8704
    v_mfma_f32_16x16x32_bf16 v[68:71], a[28:31], a[108:111], v[68:71]
    buffer_load_dwordx4 v94, s[8:11], s70 offen offset:2048 lds
    v_mfma_f32_16x16x32_bf16 v[72:75], a[28:31], a[112:115], v[72:75]
    s_mul_i32 s1, s60, 10240
    ds_read_b64_tr_b16 a[40:41], v90 offset:8192
    ds_read_b64_tr_b16 a[42:43], v90 offset:8704
    v_mfma_f32_16x16x32_bf16 v[52:55], a[24:27], a[112:115], v[52:55]
    s_add_u32 s0, s1, 84480
    ds_read_b64_tr_b16 a[56:57], v90 offset:12288
    ds_read_b64_tr_b16 a[58:59], v90 offset:12800
    v_mfma_f32_16x16x32_bf16 v[32:35], a[20:23], a[112:115], v[32:35]
    buffer_load_dwordx4 v95, s[8:11], s70 offen offset:3072 lds
    v_mfma_f32_16x16x32_bf16 v[12:15], a[16:19], a[112:115], v[12:15]
    s_add_u32 m0, s71, 4096
    ds_read_b64_tr_b16 a[60:61], v91 offset:12288
    ds_read_b64_tr_b16 a[62:63], v91 offset:12800
    v_mfma_f32_16x16x32_bf16 v[16:19], a[16:19], a[116:119], v[16:19]
    s_add_u32 s70, s34, 1310720
    ds_read_b64_tr_b16 a[44:45], v91 offset:8192
    ds_read_b64_tr_b16 a[46:47], v91 offset:8704
    v_mfma_f32_16x16x32_bf16 v[36:39], a[20:23], a[116:119], v[36:39]
    s_and_b32 s70, s70, 4194303
    ds_read_b128 a[104:107], v82 offset:16384
    ds_read_b128 a[108:111], v83 offset:16384
    v_mfma_f32_16x16x32_bf16 v[56:59], a[24:27], a[116:119], v[56:59]
    s_add_u32 s70, s70, s33
    v_add_u32 v243, s66, v100
    v_add_u32 v99, s65, v99
    v_mfma_f32_16x16x32_bf16 v[76:79], a[28:31], a[116:119], v[76:79]
    s_waitcnt lgkmcnt(7)
    v_add_u32 v237, s1, v254
    v_mfma_f32_16x16x32_bf16 v[0:3], a[32:35], a[120:123], v[0:3]
    buffer_load_dwordx4 v92, s[8:11], s70 offen offset:0 lds
    v_mfma_f32_16x16x32_bf16 v[0:3], a[48:51], a[124:127], v[0:3]
    s_and_b32 s65, s60, 2
    s_xor_b32 s66, s65, 0
    v_xor_b32 v100, s66, v98
    v_mfma_f32_16x16x32_bf16 v[20:23], a[52:55], a[124:127], v[20:23]
    s_waitcnt lgkmcnt(4)
    v_lshl_add_u32 v231, v100, 5, v99
    v_mfma_f32_16x16x32_bf16 v[20:23], a[36:39], a[120:123], v[20:23]
    buffer_load_dwordx4 v93, s[8:11], s70 offen offset:1024 lds
    v_mfma_f32_16x16x32_bf16 v[40:43], a[40:43], a[120:123], v[40:43]
    s_waitcnt lgkmcnt(2)
    s_xor_b32 s66, s65, 1
    v_xor_b32 v100, s66, v98
    v_mfma_f32_16x16x32_bf16 v[40:43], a[56:59], a[124:127], v[40:43]
    s_xor_b32 s66, s65, 2
    v_lshl_add_u32 v232, v100, 5, v99
    v_xor_b32 v100, s66, v98
    v_mfma_f32_16x16x32_bf16 v[60:63], a[60:63], a[124:127], v[60:63]
    buffer_load_dwordx4 v94, s[8:11], s70 offen offset:2048 lds
    v_mfma_f32_16x16x32_bf16 v[60:63], a[44:47], a[120:123], v[60:63]
    s_xor_b32 s66, s65, 3
    v_lshl_add_u32 v233, v100, 5, v99
    v_xor_b32 v100, s66, v98
    v_mfma_f32_16x16x32_bf16 v[64:67], a[44:47], a[80:83], v[64:67]
    s_add_u32 s65, s71, 6144
    v_lshl_add_u32 v234, v100, 5, v99
    v_and_b32 v98, 1, v103
    v_mfma_f32_16x16x32_bf16 v[64:67], a[60:63], a[84:87], v[64:67]
    buffer_load_dwordx4 v95, s[8:11], s70 offen offset:3072 lds
    v_mfma_f32_16x16x32_bf16 v[44:47], a[56:59], a[84:87], v[44:47]
    s_add_u32 m0, s71, 8192
    v_lshlrev_b32 v98, 3, v98
    v_lshrrev_b32 v99, 5, v255
    v_mfma_f32_16x16x32_bf16 v[44:47], a[40:43], a[80:83], v[44:47]
    s_add_u32 s70, s34, 1572864
    v_lshl_add_u32 v98, v102, 4, v98
    v_lshl_add_u32 v98, v99, 8, v98
    v_mfma_f32_16x16x32_bf16 v[24:27], a[36:39], a[80:83], v[24:27]
    s_and_b32 s70, s70, 4194303
    v_add_u32 v198, s65, v98
    v_and_b32 v98, 3, v255
    v_mfma_f32_16x16x32_bf16 v[24:27], a[52:55], a[84:87], v[24:27]
    s_add_u32 s70, s70, s33
    v_cmp_eq_u32 vcc, 0, v98
    v_mfma_f32_16x16x32_bf16 v[4:7], a[48:51], a[84:87], v[4:7]
    buffer_load_dwordx4 v92, s[8:11], s70 offen offset:0 lds
    v_mfma_f32_16x16x32_bf16 v[4:7], a[32:35], a[80:83], v[4:7]
    s_and_b32 s65, s60, 2
    v_cndmask_b32 v224, 0, v224, vcc
    v_cndmask_b32 v225, 0, v225, vcc
    v_mfma_f32_16x16x32_bf16 v[8:11], a[32:35], a[88:91], v[8:11]
    s_mul_i32 s65, s65, 16384
    v_cndmask_b32 v226, 0, v226, vcc
    v_cndmask_b32 v227, 0, v227, vcc
    v_mfma_f32_16x16x32_bf16 v[8:11], a[48:51], a[92:95], v[8:11]
    buffer_load_dwordx4 v93, s[8:11], s70 offen offset:1024 lds
    v_mfma_f32_16x16x32_bf16 v[28:31], a[52:55], a[92:95], v[28:31]
    s_add_u32 s65, s65, 104448
    s_lshl_b32 s66, s75, 12
    s_add_u32 s66, s66, s65
    v_mfma_f32_16x16x32_bf16 v[28:31], a[36:39], a[88:91], v[28:31]
    s_add_u32 s65, s65, 8192
    v_add_u32 v197, s66, v254
    v_add_u32 v196, s65, v254
    v_mfma_f32_16x16x32_bf16 v[48:51], a[40:43], a[88:91], v[48:51]
    buffer_load_dwordx4 v94, s[8:11], s70 offen offset:2048 lds
    v_mfma_f32_16x16x32_bf16 v[48:51], a[56:59], a[92:95], v[48:51]
    s_cmp_lt_u32 s60, 2
    s_cselect_b32 s65, 40960, 0
    s_cselect_b32 s66, 0, 151040
    s_add_u32 s65, s65, s66
    s_lshl_b32 s66, s75, 12
    v_mfma_f32_16x16x32_bf16 v[68:71], a[60:63], a[92:95], v[68:71]
    s_add_u32 s67, s65, s66
    v_add_u32 v238, s67, v254
    v_mfma_f32_16x16x32_bf16 v[68:71], a[44:47], a[88:91], v[68:71]
    buffer_load_dwordx4 v95, s[8:11], s70 offen offset:3072 lds
    v_mfma_f32_16x16x32_bf16 v[72:75], a[44:47], a[96:99], v[72:75]
    s_add_u32 m0, s71, 12288
    s_add_u32 s70, s34, 1835008
    s_and_b32 s70, s70, 4194303
    v_mfma_f32_16x16x32_bf16 v[72:75], a[60:63], a[100:103], v[72:75]
    s_add_u32 s70, s70, s33
    s_xor_b32 s66, s66, 4096
    s_add_u32 s67, s65, s66
    v_mfma_f32_16x16x32_bf16 v[52:55], a[56:59], a[100:103], v[52:55]
    buffer_load_dwordx4 v92, s[8:11], s70 offen offset:0 lds
    v_mfma_f32_16x16x32_bf16 v[52:55], a[40:43], a[96:99], v[52:55]
    s_waitcnt vmcnt(9)
    ds_read_b64_tr_b16 a[64:65], v88 offset:0
    ds_read_b64_tr_b16 a[66:67], v88 offset:512
    v_mfma_f32_16x16x32_bf16 v[32:35], a[36:39], a[96:99], v[32:35]
    s_cmp_eq_u32 s60, 3
    s_cselect_b32 s0, 151040, s0
    ds_read_b64_tr_b16 a[68:69], v89 offset:0
    ds_read_b64_tr_b16 a[70:71], v89 offset:512
    v_mfma_f32_16x16x32_bf16 v[32:35], a[52:55], a[100:103], v[32:35]
    buffer_load_dwordx4 v93, s[8:11], s70 offen offset:1024 lds
    v_mfma_f32_16x16x32_bf16 v[12:15], a[48:51], a[100:103], v[12:15]
    s_barrier
    ds_read_b128 a[112:115], v80 offset:20480
    ds_read_b128 a[116:119], v81 offset:20480
    v_mfma_f32_16x16x32_bf16 v[12:15], a[32:35], a[96:99], v[12:15]
    s_waitcnt lgkmcnt(6)
    ds_read_b64_tr_b16 a[72:73], v90 offset:0
    ds_read_b64_tr_b16 a[74:75], v90 offset:512
    v_mfma_f32_16x16x32_bf16 v[16:19], a[32:35], a[104:107], v[16:19]
    buffer_load_dwordx4 v94, s[8:11], s70 offen offset:2048 lds
    buffer_load_dwordx4 v95, s[8:11], s70 offen offset:3072 lds
    s_add_u32 m0, s69, 40960
    s_add_u32 s70, s34, 2097152
    s_and_b32 s70, s70, 4194303
    s_add_u32 s70, s70, s33
    s_add_u32 s52, s80, 0
    s_and_b32 s52, s52, 3
    s_lshl_b32 s52, s52, 18
    s_add_u32 s53, s80, 1
    s_and_b32 s53, s53, 3
    s_sub_u32 s53, s53, s80
    s_mul_i32 s53, s53, 327680
    s_waitcnt vmcnt(8)
    ds_read_b64_tr_b16 a[0:1], v88 offset:4096
    ds_read_b64_tr_b16 a[2:3], v88 offset:4608
    v_mfma_f32_16x16x32_bf16 v[16:19], a[48:51], a[108:111], v[16:19]
    s_lshl_b32 s65, s60, 8
    ds_read_b64_tr_b16 a[4:5], v89 offset:4096
    ds_read_b64_tr_b16 a[6:7], v89 offset:4608
    v_mfma_f32_16x16x32_bf16 v[36:39], a[52:55], a[108:111], v[36:39]
    s_add_u32 s66, s65, 161280
    ds_read_b64_tr_b16 a[8:9], v90 offset:4096
    ds_read_b64_tr_b16 a[10:11], v90 offset:4608
    v_mfma_f32_16x16x32_bf16 v[36:39], a[36:39], a[104:107], v[36:39]
    s_xor_b32 s65, s65, 256
    ds_read_b64_tr_b16 a[12:13], v91 offset:4096
    ds_read_b64_tr_b16 a[14:15], v91 offset:4608
    v_mfma_f32_16x16x32_bf16 v[56:59], a[40:43], a[104:107], v[56:59]
    s_mul_i32 s73, s60, 4224
    ds_read_b64_tr_b16 a[76:77], v91 offset:0
    ds_read_b64_tr_b16 a[78:79], v91 offset:512
    v_mfma_f32_16x16x32_bf16 v[56:59], a[56:59], a[108:111], v[56:59]
    s_lshl_b32 s77, s60, 12
    ds_read_b128 a[120:123], v80 offset:24576
    ds_read_b128 a[124:127], v81 offset:24576
    v_mfma_f32_16x16x32_bf16 v[76:79], a[60:63], a[108:111], v[76:79]
    s_lshl_b32 s78, s75, 1
    ds_read_b128 a[80:83], v80 offset:28672
    v_add_u32 v239, s67, v254
    v_mfma_f32_16x16x32_bf16 v[76:79], a[44:47], a[104:107], v[76:79]
    s_waitcnt lgkmcnt(10)
    ds_read_b128 a[84:87], v81 offset:28672
    v_lshl_add_u32 v235, v255, 2, s66
    v_mfma_f32_16x16x32_bf16 v[0:3], a[64:67], a[112:115], v[0:3]
    s_add_u32 s66, s65, 161280
    ds_read_b128 a[88:91], v80 offset:32768
    v_lshl_add_u32 v236, v255, 2, s66
    v_mfma_f32_16x16x32_bf16 v[0:3], a[0:3], a[116:119], v[0:3]
    s_waitcnt lgkmcnt(8)
    ds_read_b128 a[92:95], v81 offset:32768
    v_mfma_f32_16x16x32_bf16 v[20:23], a[4:7], a[116:119], v[20:23]
    s_waitcnt lgkmcnt(8)
    ds_read_b128 a[96:99], v80 offset:36864
    v_mfma_f32_16x16x32_bf16 v[20:23], a[68:71], a[112:115], v[20:23]
    s_waitcnt lgkmcnt(7)
    ds_read_b128 a[100:103], v81 offset:36864
    v_mfma_f32_16x16x32_bf16 v[40:43], a[72:75], a[112:115], v[40:43]
    s_lshr_b32 s65, s63, 1
    ds_read_b128 a[104:107], v82 offset:20480
    v_mfma_f32_16x16x32_bf16 v[40:43], a[8:11], a[116:119], v[40:43]
    s_lshl_b32 s66, s62, 3
    ds_read_b128 a[108:111], v83 offset:20480
    v_mfma_f32_16x16x32_bf16 v[60:63], a[12:15], a[116:119], v[60:63]
    s_add_u32 s65, s65, s66
    ds_read_b128 a[116:119], v83 offset:24576
    v_mfma_f32_16x16x32_bf16 v[60:63], a[76:79], a[112:115], v[60:63]
    s_waitcnt lgkmcnt(7)
    ds_read_b128 a[112:115], v82 offset:24576
    v_mfma_f32_16x16x32_bf16 v[64:67], a[76:79], a[120:123], v[64:67]
    s_lshl_b32 s65, s65, 17
    s_lshl_b32 s66, s60, 10
    s_add_u32 s40, s65, s66
    v_mfma_f32_16x16x32_bf16 v[64:67], a[12:15], a[124:127], v[64:67]
    s_add_u32 s72, s40, 0
    s_add_u32 s74, s40, 0
    s_and_b32 s65, s41, 3
    v_mfma_f32_16x16x32_bf16 v[44:47], a[8:11], a[124:127], v[44:47]
    buffer_load_dwordx4 v193, s[4:7], s68 offen offset:0 lds
    v_mfma_f32_16x16x32_bf16 v[44:47], a[72:75], a[120:123], v[44:47]
    s_add_u32 m0, s69, 45056
    s_add_u32 s68, s37, 16384
    s_lshl_b32 s76, s65, 20
    v_mfma_f32_16x16x32_bf16 v[24:27], a[68:71], a[120:123], v[24:27]
    s_lshr_b32 s66, s60, 1
    s_lshl_b32 s66, s66, 17
    s_add_u32 s76, s76, s66
    v_mfma_f32_16x16x32_bf16 v[24:27], a[4:7], a[124:127], v[24:27]
    buffer_load_dwordx4 v193, s[4:7], s68 offen offset:0 lds
    v_mfma_f32_16x16x32_bf16 v[4:7], a[0:3], a[124:127], v[4:7]
    s_add_u32 m0, s69, 49152
    ds_read_b128 a[124:127], v83 offset:28672
    v_mfma_f32_16x16x32_bf16 v[4:7], a[64:67], a[120:123], v[4:7]
    s_add_u32 s68, s37, 32768
    ds_read_b128 a[120:123], v82 offset:28672
    v_mfma_f32_16x16x32_bf16 v[8:11], a[64:67], a[80:83], v[8:11]
    buffer_load_dwordx4 v193, s[4:7], s68 offen offset:0 lds
    v_mfma_f32_16x16x32_bf16 v[8:11], a[0:3], a[84:87], v[8:11]
    s_add_u32 m0, s69, 53248
    s_add_u32 s68, s37, 49152
    s_lshr_b32 s66, s41, 2
    v_mfma_f32_16x16x32_bf16 v[28:31], a[4:7], a[84:87], v[28:31]
    s_lshl_b32 s66, s66, 8
    s_add_u32 s76, s76, s66
    s_lshl_b32 s66, s75, 7
    v_mfma_f32_16x16x32_bf16 v[28:31], a[68:71], a[80:83], v[28:31]
    buffer_load_dwordx4 v193, s[4:7], s68 offen offset:0 lds
    v_mfma_f32_16x16x32_bf16 v[48:51], a[72:75], a[80:83], v[48:51]
    s_add_u32 m0, s69, 57344
    s_add_u32 s68, s37, 65536
    s_add_u32 s76, s76, s66
    v_mfma_f32_16x16x32_bf16 v[48:51], a[8:11], a[84:87], v[48:51]
    s_waitcnt vmcnt(8)
    ds_read_b64_tr_b16 a[16:17], v88 offset:8192
    ds_read_b64_tr_b16 a[18:19], v88 offset:8704
    v_mfma_f32_16x16x32_bf16 v[68:71], a[12:15], a[84:87], v[68:71]
    buffer_load_dwordx4 v193, s[4:7], s68 offen offset:0 lds
    v_mfma_f32_16x16x32_bf16 v[68:71], a[76:79], a[80:83], v[68:71]
    s_waitcnt lgkmcnt(2)
    ds_read_b64_tr_b16 a[20:21], v89 offset:8192
    ds_read_b64_tr_b16 a[22:23], v89 offset:8704
    v_mfma_f32_16x16x32_bf16 v[72:75], a[76:79], a[88:91], v[72:75]
    s_add_u32 m0, s71, 0
    ds_read_b64_tr_b16 a[24:25], v90 offset:8192
    ds_read_b64_tr_b16 a[26:27], v90 offset:8704
    v_mfma_f32_16x16x32_bf16 v[72:75], a[12:15], a[92:95], v[72:75]
    buffer_load_dwordx4 v92, s[8:11], s70 offen offset:0 lds
    v_mfma_f32_16x16x32_bf16 v[52:55], a[8:11], a[92:95], v[52:55]
    s_add_u32 s68, s37, 0
    ds_read_b64_tr_b16 a[28:29], v91 offset:8192
    ds_read_b64_tr_b16 a[30:31], v91 offset:8704
    v_mfma_f32_16x16x32_bf16 v[52:55], a[72:75], a[88:91], v[52:55]
    s_waitcnt vmcnt(6)
    ds_read_b64_tr_b16 a[32:33], v88 offset:12288
    ds_read_b64_tr_b16 a[34:35], v88 offset:12800
    v_mfma_f32_16x16x32_bf16 v[32:35], a[68:71], a[88:91], v[32:35]
    buffer_load_dwordx4 v93, s[8:11], s70 offen offset:1024 lds
    v_mfma_f32_16x16x32_bf16 v[32:35], a[4:7], a[92:95], v[32:35]
    s_lshl_b32 s67, s42, 4
    ds_read_b64_tr_b16 a[36:37], v89 offset:12288
    ds_read_b64_tr_b16 a[38:39], v89 offset:12800
    v_mfma_f32_16x16x32_bf16 v[12:15], a[0:3], a[92:95], v[12:15]
    s_and_b32 s66, s41, 12
    ds_read_b64_tr_b16 a[40:41], v90 offset:12288
    ds_read_b64_tr_b16 a[42:43], v90 offset:12800
    v_mfma_f32_16x16x32_bf16 v[12:15], a[64:67], a[88:91], v[12:15]
    buffer_load_dwordx4 v94, s[8:11], s70 offen offset:2048 lds
    v_mfma_f32_16x16x32_bf16 v[16:19], a[64:67], a[96:99], v[16:19]
    s_add_u32 s66, s66, s67
    ds_read_b64_tr_b16 a[44:45], v91 offset:12288
    ds_read_b64_tr_b16 a[46:47], v91 offset:12800
    v_mfma_f32_16x16x32_bf16 v[16:19], a[0:3], a[100:103], v[16:19]
    s_waitcnt lgkmcnt(8)
    ds_read_b128 a[80:83], v82 offset:32768
    ds_read_b128 a[84:87], v83 offset:32768
    v_mfma_f32_16x16x32_bf16 v[36:39], a[4:7], a[100:103], v[36:39]
    buffer_load_dwordx4 v95, s[8:11], s70 offen offset:3072 lds
    v_mfma_f32_16x16x32_bf16 v[36:39], a[68:71], a[96:99], v[36:39]
    s_add_u32 m0, s69, 77824
    ds_read_b128 a[88:91], v82 offset:36864
    ds_read_b128 a[92:95], v83 offset:36864
    v_mfma_f32_16x16x32_bf16 v[56:59], a[72:75], a[96:99], v[56:59]
    buffer_load_dwordx4 v194, s[4:7], s68 offen offset:0 lds
    v_mfma_f32_16x16x32_bf16 v[56:59], a[8:11], a[100:103], v[56:59]
    s_add_u32 m0, s71, 4096
    s_add_u32 s70, s34, 2359296
    s_and_b32 s70, s70, 4194303
    v_mfma_f32_16x16x32_bf16 v[76:79], a[12:15], a[100:103], v[76:79]
    s_add_u32 s70, s70, s33
    s_add_u32 s68, s37, 16384
    s_add_u32 s66, s66, s78
    v_mfma_f32_16x16x32_bf16 v[76:79], a[76:79], a[96:99], v[76:79]
    buffer_load_dwordx4 v92, s[8:11], s70 offen offset:0 lds
    v_mfma_f32_16x16x32_bf16 v[0:3], a[16:19], a[104:107], v[0:3]
    s_waitcnt lgkmcnt(3)
    s_lshr_b32 s78, s60, 1
    s_add_u32 s66, s66, s78
    v_mfma_f32_16x16x32_bf16 v[0:3], a[32:35], a[108:111], v[0:3]
    s_lshl_b32 s66, s66, 2
    s_add_u32 s66, s66, s65
    v_mfma_f32_16x16x32_bf16 v[20:23], a[36:39], a[108:111], v[20:23]
    buffer_load_dwordx4 v93, s[8:11], s70 offen offset:1024 lds
    v_mfma_f32_16x16x32_bf16 v[20:23], a[20:23], a[104:107], v[20:23]
    s_mul_i32 s66, s66, 6144
    s_add_u32 s78, s66, 1048576
    s_add_u32 s67, s67, s41
    v_mfma_f32_16x16x32_bf16 v[40:43], a[24:27], a[104:107], v[40:43]
    s_mul_i32 s67, s67, 24576
    s_add_u32 s43, s67, 1048576
    s_lshl_b32 s65, s2, 2
    v_mfma_f32_16x16x32_bf16 v[40:43], a[40:43], a[108:111], v[40:43]
    buffer_load_dwordx4 v94, s[8:11], s70 offen offset:2048 lds
    v_mfma_f32_16x16x32_bf16 v[60:63], a[44:47], a[108:111], v[60:63]
    s_add_u32 s65, s65, s60
    s_mul_i32 s3, s65, 10240
    s_add_u32 s3, s3, 8388608
    v_mfma_f32_16x16x32_bf16 v[60:63], a[28:31], a[104:107], v[60:63]
    s_lshl_b32 s47, s65, 7
    s_add_u32 s47, s47, 524288
    s_andn2_b32 s59, s2, 24
    v_mfma_f32_16x16x32_bf16 v[64:67], a[28:31], a[112:115], v[64:67]
    buffer_load_dwordx4 v95, s[8:11], s70 offen offset:3072 lds
    v_mfma_f32_16x16x32_bf16 v[64:67], a[44:47], a[116:119], v[64:67]
    s_add_u32 m0, s69, 81920
    s_add_u32 s70, s34, 2621440
    s_and_b32 s70, s70, 4194303
    v_mfma_f32_16x16x32_bf16 v[44:47], a[40:43], a[116:119], v[44:47]
    buffer_load_dwordx4 v194, s[4:7], s68 offen offset:0 lds
    v_mfma_f32_16x16x32_bf16 v[44:47], a[24:27], a[112:115], v[44:47]
    s_add_u32 m0, s71, 8192
    s_add_u32 s70, s70, s33
    s_add_u32 s68, s37, 32768
    v_mfma_f32_16x16x32_bf16 v[24:27], a[20:23], a[112:115], v[24:27]
    s_lshl_b32 s59, s59, 7
    s_lshl_b32 s65, s60, 2
    s_add_u32 s59, s59, s65
    v_mfma_f32_16x16x32_bf16 v[24:27], a[36:39], a[116:119], v[24:27]
    buffer_load_dwordx4 v92, s[8:11], s70 offen offset:0 lds
    v_mfma_f32_16x16x32_bf16 v[4:7], a[32:35], a[116:119], v[4:7]
    s_add_u32 s59, s59, 262144
    s_mul_i32 s65, s62, 163840
    s_lshl_b32 s66, s61, 10
    v_mfma_f32_16x16x32_bf16 v[4:7], a[16:19], a[112:115], v[4:7]
    s_add_u32 s65, s65, s66
    s_lshl_b32 s66, s41, 6
    s_add_u32 s65, s65, s66
    v_mfma_f32_16x16x32_bf16 v[8:11], a[16:19], a[120:123], v[8:11]
    buffer_load_dwordx4 v93, s[8:11], s70 offen offset:1024 lds
    v_mfma_f32_16x16x32_bf16 v[8:11], a[32:35], a[124:127], v[8:11]
    s_lshl_b32 s66, s60, 4
    s_add_u32 s44, s65, s66
    s_mov_b32 s81, 0x3e0293ee
    v_mfma_f32_16x16x32_bf16 v[28:31], a[36:39], a[124:127], v[28:31]
    s_mov_b32 s54, 0xffff0000
    s_mov_b32 s55, 0xffff0000
    s_add_u32 s52, s52, s76
    v_mfma_f32_16x16x32_bf16 v[28:31], a[20:23], a[120:123], v[28:31]
    buffer_load_dwordx4 v94, s[8:11], s70 offen offset:2048 lds
    v_mfma_f32_16x16x32_bf16 v[48:51], a[24:27], a[120:123], v[48:51]
    s_add_u32 s53, s53, s3
    s_add_u32 s56, s3, 4096
    s_add_u32 s57, s3, 8192
    v_mfma_f32_16x16x32_bf16 v[48:51], a[40:43], a[124:127], v[48:51]
    s_lshl_b32 s67, s60, 2
    s_add_u32 s67, s67, 162304
    v_mfma_f32_16x16x32_bf16 v[68:71], a[44:47], a[124:127], v[68:71]
    buffer_load_dwordx4 v95, s[8:11], s70 offen offset:3072 lds
    v_mfma_f32_16x16x32_bf16 v[68:71], a[28:31], a[120:123], v[68:71]
    s_add_u32 m0, s69, 86016
    s_add_u32 s70, s34, 2883584
    s_and_b32 s70, s70, 4194303
    v_mfma_f32_16x16x32_bf16 v[72:75], a[28:31], a[80:83], v[72:75]
    s_waitcnt lgkmcnt(0)
    s_add_u32 s70, s70, s33
    v_mfma_f32_16x16x32_bf16 v[72:75], a[44:47], a[84:87], v[72:75]
    buffer_load_dwordx4 v194, s[4:7], s68 offen offset:0 lds
    v_mfma_f32_16x16x32_bf16 v[52:55], a[40:43], a[84:87], v[52:55]
    s_add_u32 m0, s71, 12288
    s_add_u32 s68, s37, 49152
    v_mfma_f32_16x16x32_bf16 v[52:55], a[24:27], a[80:83], v[52:55]
    s_waitcnt vmcnt(11)
    ds_read_b64_tr_b16 a[48:49], v88 offset:0
    ds_read_b64_tr_b16 a[50:51], v88 offset:512
    v_mfma_f32_16x16x32_bf16 v[32:35], a[20:23], a[80:83], v[32:35]
    buffer_load_dwordx4 v92, s[8:11], s70 offen offset:0 lds
    v_mfma_f32_16x16x32_bf16 v[32:35], a[36:39], a[84:87], v[32:35]
    s_barrier
    ds_read_b128 a[96:99], v80 offset:40960
    ds_read_b128 a[100:103], v81 offset:40960
    v_mfma_f32_16x16x32_bf16 v[12:15], a[32:35], a[84:87], v[12:15]
    buffer_load_dwordx4 v93, s[8:11], s70 offen offset:1024 lds
    v_mfma_f32_16x16x32_bf16 v[12:15], a[16:19], a[80:83], v[12:15]
    ds_read_b64_tr_b16 a[52:53], v89 offset:0
    ds_read_b64_tr_b16 a[54:55], v89 offset:512
    v_mfma_f32_16x16x32_bf16 v[16:19], a[16:19], a[88:91], v[16:19]
    buffer_load_dwordx4 v94, s[8:11], s70 offen offset:2048 lds
    buffer_load_dwordx4 v95, s[8:11], s70 offen offset:3072 lds
    s_add_u32 m0, s69, 90112
    s_add_u32 s70, s34, 3145728
    s_and_b32 s70, s70, 4194303
    s_add_u32 s70, s70, s33
    s_waitcnt vmcnt(10)
    ds_read_b64_tr_b16 a[64:65], v88 offset:4096
    ds_read_b64_tr_b16 a[66:67], v88 offset:4608
    v_mfma_f32_16x16x32_bf16 v[16:19], a[32:35], a[92:95], v[16:19]
    ds_read_b64_tr_b16 a[68:69], v89 offset:4096
    ds_read_b64_tr_b16 a[70:71], v89 offset:4608
    v_mfma_f32_16x16x32_bf16 v[36:39], a[36:39], a[92:95], v[36:39]
    ds_read_b64_tr_b16 a[56:57], v90 offset:0
    ds_read_b64_tr_b16 a[58:59], v90 offset:512
    v_mfma_f32_16x16x32_bf16 v[36:39], a[20:23], a[88:91], v[36:39]
    ds_read_b64_tr_b16 a[72:73], v90 offset:4096
    ds_read_b64_tr_b16 a[74:75], v90 offset:4608
    v_mfma_f32_16x16x32_bf16 v[56:59], a[24:27], a[88:91], v[56:59]
    ds_read_b64_tr_b16 a[76:77], v91 offset:4096
    ds_read_b64_tr_b16 a[78:79], v91 offset:4608
    v_mfma_f32_16x16x32_bf16 v[56:59], a[40:43], a[92:95], v[56:59]
    ds_read_b64_tr_b16 a[60:61], v91 offset:0
    ds_read_b64_tr_b16 a[62:63], v91 offset:512
    v_mfma_f32_16x16x32_bf16 v[76:79], a[44:47], a[92:95], v[76:79]
    ds_read_b128 a[104:107], v80 offset:45056
    ds_read_b128 a[108:111], v81 offset:45056
    v_mfma_f32_16x16x32_bf16 v[76:79], a[28:31], a[88:91], v[76:79]
    s_waitcnt lgkmcnt(11)
    ds_read_b128 a[112:115], v80 offset:49152
    v_mfma_f32_16x16x32_bf16 v[0:3], a[48:51], a[96:99], v[0:3]
    ds_read_b128 a[116:119], v81 offset:49152
    v_mfma_f32_16x16x32_bf16 v[0:3], a[64:67], a[100:103], v[0:3]
    s_waitcnt lgkmcnt(9)
    ds_read_b128 a[120:123], v80 offset:53248
    v_mfma_f32_16x16x32_bf16 v[20:23], a[68:71], a[100:103], v[20:23]
    ds_read_b128 a[124:127], v81 offset:53248
    v_mfma_f32_16x16x32_bf16 v[20:23], a[52:55], a[96:99], v[20:23]
    s_waitcnt lgkmcnt(8)
    ds_read_b128 a[80:83], v80 offset:57344
    v_mfma_f32_16x16x32_bf16 v[40:43], a[56:59], a[96:99], v[40:43]
    s_waitcnt lgkmcnt(7)
    ds_read_b128 a[84:87], v81 offset:57344
    v_mfma_f32_16x16x32_bf16 v[40:43], a[72:75], a[100:103], v[40:43]
    buffer_load_dwordx4 v194, s[4:7], s68 offen offset:0 lds
    v_mfma_f32_16x16x32_bf16 v[60:63], a[76:79], a[100:103], v[60:63]
    s_add_u32 m0, s69, 94208
    ds_read_b128 a[88:91], v82 offset:40960
    ds_read_b128 a[92:95], v83 offset:40960
    v_mfma_f32_16x16x32_bf16 v[60:63], a[60:63], a[96:99], v[60:63]
    s_waitcnt lgkmcnt(7)
    ds_read_b128 a[96:99], v82 offset:45056
    v_mfma_f32_16x16x32_bf16 v[64:67], a[60:63], a[104:107], v[64:67]
    s_add_u32 s68, s37, 65536
    ds_read_b128 a[100:103], v83 offset:45056
    v_mfma_f32_16x16x32_bf16 v[64:67], a[76:79], a[108:111], v[64:67]
    buffer_load_dwordx4 v194, s[4:7], s68 offen offset:0 lds
    v_mfma_f32_16x16x32_bf16 v[44:47], a[72:75], a[108:111], v[44:47]
    s_add_u32 m0, s71, 0
    v_mfma_f32_16x16x32_bf16 v[44:47], a[56:59], a[104:107], v[44:47]
    v_mfma_f32_16x16x32_bf16 v[24:27], a[52:55], a[104:107], v[24:27]
    buffer_load_dwordx4 v92, s[8:11], s70 offen offset:0 lds
    v_mfma_f32_16x16x32_bf16 v[24:27], a[68:71], a[108:111], v[24:27]
    v_mfma_f32_16x16x32_bf16 v[4:7], a[64:67], a[108:111], v[4:7]
    ds_read_b128 a[108:111], v83 offset:49152
    v_mfma_f32_16x16x32_bf16 v[4:7], a[48:51], a[104:107], v[4:7]
    buffer_load_dwordx4 v93, s[8:11], s70 offen offset:1024 lds
    v_mfma_f32_16x16x32_bf16 v[8:11], a[48:51], a[112:115], v[8:11]
    s_waitcnt lgkmcnt(1)
    ds_read_b128 a[104:107], v82 offset:49152
    v_mfma_f32_16x16x32_bf16 v[8:11], a[64:67], a[116:119], v[8:11]
    v_mfma_f32_16x16x32_bf16 v[28:31], a[68:71], a[116:119], v[28:31]
    buffer_load_dwordx4 v94, s[8:11], s70 offen offset:2048 lds
    v_mfma_f32_16x16x32_bf16 v[28:31], a[52:55], a[112:115], v[28:31]
    v_mfma_f32_16x16x32_bf16 v[48:51], a[56:59], a[112:115], v[48:51]
    v_mfma_f32_16x16x32_bf16 v[48:51], a[72:75], a[116:119], v[48:51]
    buffer_load_dwordx4 v95, s[8:11], s70 offen offset:3072 lds
    v_mfma_f32_16x16x32_bf16 v[68:71], a[76:79], a[116:119], v[68:71]
    s_add_u32 m0, s71, 4096
    ds_read_b128 a[116:119], v83 offset:53248
    v_mfma_f32_16x16x32_bf16 v[68:71], a[60:63], a[112:115], v[68:71]
    s_add_u32 s70, s34, 3407872
    ds_read_b128 a[112:115], v82 offset:53248
    v_mfma_f32_16x16x32_bf16 v[72:75], a[60:63], a[120:123], v[72:75]
    s_and_b32 s70, s70, 4194303
    s_add_u32 s70, s70, s33
    v_mfma_f32_16x16x32_bf16 v[72:75], a[76:79], a[124:127], v[72:75]
    buffer_load_dwordx4 v92, s[8:11], s70 offen offset:0 lds
    v_mfma_f32_16x16x32_bf16 v[52:55], a[72:75], a[124:127], v[52:55]
    s_waitcnt vmcnt(12)
    ds_read_b64_tr_b16 a[0:1], v88 offset:8192
    ds_read_b64_tr_b16 a[2:3], v88 offset:8704
    v_mfma_f32_16x16x32_bf16 v[52:55], a[56:59], a[120:123], v[52:55]
    ds_read_b64_tr_b16 a[4:5], v89 offset:8192
    ds_read_b64_tr_b16 a[6:7], v89 offset:8704
    v_mfma_f32_16x16x32_bf16 v[32:35], a[52:55], a[120:123], v[32:35]
    buffer_load_dwordx4 v93, s[8:11], s70 offen offset:1024 lds
    v_mfma_f32_16x16x32_bf16 v[32:35], a[68:71], a[124:127], v[32:35]
    ds_read_b64_tr_b16 a[8:9], v90 offset:8192
    ds_read_b64_tr_b16 a[10:11], v90 offset:8704
    v_mfma_f32_16x16x32_bf16 v[12:15], a[64:67], a[124:127], v[12:15]
    ds_read_b64_tr_b16 a[12:13], v91 offset:8192
    ds_read_b64_tr_b16 a[14:15], v91 offset:8704
    v_mfma_f32_16x16x32_bf16 v[12:15], a[48:51], a[120:123], v[12:15]
    buffer_load_dwordx4 v94, s[8:11], s70 offen offset:2048 lds
    v_mfma_f32_16x16x32_bf16 v[16:19], a[48:51], a[80:83], v[16:19]
    buffer_load_dwordx4 v95, s[8:11], s70 offen offset:3072 lds
    s_add_u32 m0, s71, 8192
    s_waitcnt vmcnt(10)
    ds_read_b64_tr_b16 a[16:17], v88 offset:12288
    ds_read_b64_tr_b16 a[18:19], v88 offset:12800
    v_mfma_f32_16x16x32_bf16 v[16:19], a[64:67], a[84:87], v[16:19]
    s_add_u32 s70, s34, 3670016
    ds_read_b64_tr_b16 a[20:21], v89 offset:12288
    ds_read_b64_tr_b16 a[22:23], v89 offset:12800
    v_mfma_f32_16x16x32_bf16 v[36:39], a[68:71], a[84:87], v[36:39]
    s_and_b32 s70, s70, 4194303
    ds_read_b64_tr_b16 a[24:25], v90 offset:12288
    ds_read_b64_tr_b16 a[26:27], v90 offset:12800
    v_mfma_f32_16x16x32_bf16 v[36:39], a[52:55], a[80:83], v[36:39]
    s_waitcnt lgkmcnt(6)
    ds_read_b64_tr_b16 a[28:29], v91 offset:12288
    ds_read_b64_tr_b16 a[30:31], v91 offset:12800
    v_mfma_f32_16x16x32_bf16 v[56:59], a[56:59], a[80:83], v[56:59]
    s_add_u32 s70, s70, s33
    ds_read_b128 a[120:123], v82 offset:57344
    ds_read_b128 a[124:127], v83 offset:57344
    v_mfma_f32_16x16x32_bf16 v[56:59], a[72:75], a[84:87], v[56:59]
    buffer_load_dwordx4 v92, s[8:11], s70 offen offset:0 lds
    v_mfma_f32_16x16x32_bf16 v[76:79], a[76:79], a[84:87], v[76:79]
    v_mfma_f32_16x16x32_bf16 v[76:79], a[60:63], a[80:83], v[76:79]
    v_mfma_f32_16x16x32_bf16 v[0:3], a[0:3], a[88:91], v[0:3]
    s_waitcnt lgkmcnt(5)
    v_mfma_f32_16x16x32_bf16 v[0:3], a[16:19], a[92:95], v[0:3]
    buffer_load_dwordx4 v93, s[8:11], s70 offen offset:1024 lds
    v_mfma_f32_16x16x32_bf16 v[20:23], a[20:23], a[92:95], v[20:23]
    s_waitcnt lgkmcnt(2)
    v_mfma_f32_16x16x32_bf16 v[20:23], a[4:7], a[88:91], v[20:23]
    v_mfma_f32_16x16x32_bf16 v[40:43], a[8:11], a[88:91], v[40:43]
    buffer_load_dwordx4 v94, s[8:11], s70 offen offset:2048 lds
    v_mfma_f32_16x16x32_bf16 v[40:43], a[24:27], a[92:95], v[40:43]
    v_mfma_f32_16x16x32_bf16 v[60:63], a[28:31], a[92:95], v[60:63]
    v_mfma_f32_16x16x32_bf16 v[60:63], a[12:15], a[88:91], v[60:63]
    buffer_load_dwordx4 v95, s[8:11], s70 offen offset:3072 lds
    v_mfma_f32_16x16x32_bf16 v[64:67], a[12:15], a[96:99], v[64:67]
    s_add_u32 m0, s71, 12288
    s_add_u32 s70, s34, 3932160
    s_and_b32 s70, s70, 4194303
    v_mfma_f32_16x16x32_bf16 v[64:67], a[28:31], a[100:103], v[64:67]
    s_add_u32 s70, s70, s33
    v_mfma_f32_16x16x32_bf16 v[44:47], a[24:27], a[100:103], v[44:47]
    buffer_load_dwordx4 v92, s[8:11], s70 offen offset:0 lds
    v_mfma_f32_16x16x32_bf16 v[44:47], a[8:11], a[96:99], v[44:47]
    v_mfma_f32_16x16x32_bf16 v[24:27], a[4:7], a[96:99], v[24:27]
    v_mfma_f32_16x16x32_bf16 v[24:27], a[20:23], a[100:103], v[24:27]
    buffer_load_dwordx4 v93, s[8:11], s70 offen offset:1024 lds
    v_mfma_f32_16x16x32_bf16 v[4:7], a[16:19], a[100:103], v[4:7]
    v_mfma_f32_16x16x32_bf16 v[4:7], a[0:3], a[96:99], v[4:7]
    v_mfma_f32_16x16x32_bf16 v[8:11], a[0:3], a[104:107], v[8:11]
    buffer_load_dwordx4 v94, s[8:11], s70 offen offset:2048 lds
    v_mfma_f32_16x16x32_bf16 v[8:11], a[16:19], a[108:111], v[8:11]
    v_mfma_f32_16x16x32_bf16 v[28:31], a[20:23], a[108:111], v[28:31]
    v_mfma_f32_16x16x32_bf16 v[28:31], a[4:7], a[104:107], v[28:31]
    buffer_load_dwordx4 v95, s[8:11], s70 offen offset:3072 lds
    v_mfma_f32_16x16x32_bf16 v[48:51], a[8:11], a[104:107], v[48:51]
    s_add_u32 m0, s73, 0
    buffer_store_dword v191, v190, s[48:51], 0 offen offset:0 sc1
    v_mfma_f32_16x16x32_bf16 v[48:51], a[24:27], a[108:111], v[48:51]
    s_waitcnt vmcnt(13)
    ds_read_b64_tr_b16 a[32:33], v88 offset:0
    ds_read_b64_tr_b16 a[34:35], v88 offset:512
    v_mfma_f32_16x16x32_bf16 v[68:71], a[28:31], a[108:111], v[68:71]
    ds_read_b64_tr_b16 a[36:37], v89 offset:0
    ds_read_b64_tr_b16 a[38:39], v89 offset:512
    v_mfma_f32_16x16x32_bf16 v[68:71], a[12:15], a[104:107], v[68:71]
    ds_read_b64_tr_b16 a[40:41], v90 offset:0
    ds_read_b64_tr_b16 a[42:43], v90 offset:512
    v_mfma_f32_16x16x32_bf16 v[72:75], a[12:15], a[112:115], v[72:75]
    ds_read_b64_tr_b16 a[44:45], v91 offset:0
    ds_read_b64_tr_b16 a[46:47], v91 offset:512
    v_mfma_f32_16x16x32_bf16 v[72:75], a[28:31], a[116:119], v[72:75]
    v_mfma_f32_16x16x32_bf16 v[52:55], a[24:27], a[116:119], v[52:55]
    v_mfma_f32_16x16x32_bf16 v[52:55], a[8:11], a[112:115], v[52:55]
    v_mfma_f32_16x16x32_bf16 v[32:35], a[4:7], a[112:115], v[32:35]
    v_mfma_f32_16x16x32_bf16 v[32:35], a[20:23], a[116:119], v[32:35]
    s_barrier
    ds_read_b128 a[80:83], v84 offset:0
    ds_read_b128 a[84:87], v85 offset:0
    v_mfma_f32_16x16x32_bf16 v[12:15], a[16:19], a[116:119], v[12:15]
    buffer_load_dwordx4 v250, s[12:15], s72 offen offset:0 nt lds
    v_mfma_f32_16x16x32_bf16 v[12:15], a[0:3], a[112:115], v[12:15]
    s_waitcnt lgkmcnt(2)
    ds_read_b128 a[88:91], v84 offset:4096
    ds_read_b128 a[92:95], v85 offset:4096
    v_mfma_f32_16x16x32_bf16 v[16:19], a[0:3], a[120:123], v[16:19]
    s_waitcnt vmcnt(10)
    ds_read_b64_tr_b16 a[48:49], v88 offset:4096
    ds_read_b64_tr_b16 a[50:51], v88 offset:4608
    v_mfma_f32_16x16x32_bf16 v[16:19], a[16:19], a[124:127], v[16:19]
    ds_read_b64_tr_b16 a[52:53], v89 offset:4096
    ds_read_b64_tr_b16 a[54:55], v89 offset:4608
    v_mfma_f32_16x16x32_bf16 v[36:39], a[20:23], a[124:127], v[36:39]
    buffer_load_dwordx4 v251, s[12:15], s72 offen offset:1056 nt lds
    v_mfma_f32_16x16x32_bf16 v[36:39], a[4:7], a[120:123], v[36:39]
    ds_read_b64_tr_b16 a[56:57], v90 offset:4096
    ds_read_b64_tr_b16 a[58:59], v90 offset:4608
    v_mfma_f32_16x16x32_bf16 v[56:59], a[8:11], a[120:123], v[56:59]
    ds_read_b64_tr_b16 a[60:61], v91 offset:4096
    ds_read_b64_tr_b16 a[62:63], v91 offset:4608
    v_mfma_f32_16x16x32_bf16 v[56:59], a[24:27], a[124:127], v[56:59]
    buffer_load_dwordx4 v252, s[12:15], s72 offen offset:2112 nt lds
    v_mfma_f32_16x16x32_bf16 v[76:79], a[28:31], a[124:127], v[76:79]
    ds_read_b128 a[96:99], v84 offset:8192
    ds_read_b128 a[100:103], v85 offset:8192
    v_mfma_f32_16x16x32_bf16 v[76:79], a[12:15], a[120:123], v[76:79]
    s_waitcnt lgkmcnt(7)
    ds_read_b128 a[104:107], v84 offset:12288
    v_mfma_f32_16x16x32_bf16 v[0:3], a[32:35], a[80:83], v[0:3]
    buffer_load_dwordx4 v253, s[12:15], s72 offen offset:3168 nt lds
    v_mfma_f32_16x16x32_bf16 v[0:3], a[48:51], a[84:87], v[0:3]
    s_waitcnt lgkmcnt(6)
    ds_read_b128 a[108:111], v85 offset:12288
    ds_read_b128 a[112:115], v84 offset:16384
    v_mfma_f32_16x16x32_bf16 v[20:23], a[52:55], a[84:87], v[20:23]
    s_add_u32 m0, s73, 16896
    ds_read_b128 a[116:119], v85 offset:16384
    v_mfma_f32_16x16x32_bf16 v[20:23], a[36:39], a[80:83], v[20:23]
    s_add_u32 s72, s40, 16384
    ds_read_b128 a[120:123], v86 offset:0
    v_mfma_f32_16x16x32_bf16 v[40:43], a[40:43], a[80:83], v[40:43]
    s_waitcnt lgkmcnt(7)
    ds_read_b128 a[124:127], v87 offset:0
    v_mfma_f32_16x16x32_bf16 v[40:43], a[56:59], a[84:87], v[40:43]
    buffer_load_dwordx4 v250, s[12:15], s72 offen offset:0 nt lds
    v_mfma_f32_16x16x32_bf16 v[60:63], a[60:63], a[84:87], v[60:63]
    ds_read_b128 a[84:87], v87 offset:4096
    v_mfma_f32_16x16x32_bf16 v[60:63], a[44:47], a[80:83], v[60:63]
    ds_read_b128 a[80:83], v86 offset:4096
    v_mfma_f32_16x16x32_bf16 v[64:67], a[44:47], a[88:91], v[64:67]
    buffer_load_dwordx4 v251, s[12:15], s72 offen offset:1056 nt lds
    v_mfma_f32_16x16x32_bf16 v[64:67], a[60:63], a[92:95], v[64:67]
    v_mfma_f32_16x16x32_bf16 v[44:47], a[56:59], a[92:95], v[44:47]
    v_mfma_f32_16x16x32_bf16 v[44:47], a[40:43], a[88:91], v[44:47]
    buffer_load_dwordx4 v252, s[12:15], s72 offen offset:2112 nt lds
    v_mfma_f32_16x16x32_bf16 v[24:27], a[36:39], a[88:91], v[24:27]
    v_mfma_f32_16x16x32_bf16 v[24:27], a[52:55], a[92:95], v[24:27]
    v_mfma_f32_16x16x32_bf16 v[4:7], a[48:51], a[92:95], v[4:7]
    buffer_load_dwordx4 v253, s[12:15], s72 offen offset:3168 nt lds
    v_mfma_f32_16x16x32_bf16 v[4:7], a[32:35], a[88:91], v[4:7]
    s_waitcnt lgkmcnt(0)
    ds_read_b128 a[88:91], v86 offset:8192
    ds_read_b128 a[92:95], v87 offset:8192
    v_mfma_f32_16x16x32_bf16 v[8:11], a[32:35], a[96:99], v[8:11]
    s_add_u32 m0, s73, 50688
    s_add_u32 s72, s40, 32768
    v_mfma_f32_16x16x32_bf16 v[8:11], a[48:51], a[100:103], v[8:11]
    v_mfma_f32_16x16x32_bf16 v[28:31], a[52:55], a[100:103], v[28:31]
    v_mfma_f32_16x16x32_bf16 v[28:31], a[36:39], a[96:99], v[28:31]
    v_mfma_f32_16x16x32_bf16 v[48:51], a[40:43], a[96:99], v[48:51]
    v_mfma_f32_16x16x32_bf16 v[48:51], a[56:59], a[100:103], v[48:51]
    s_waitcnt vmcnt(13)
    ds_read_b64_tr_b16 a[64:65], v88 offset:8192
    ds_read_b64_tr_b16 a[66:67], v88 offset:8704
    v_mfma_f32_16x16x32_bf16 v[68:71], a[60:63], a[100:103], v[68:71]
    ds_read_b64_tr_b16 a[68:69], v89 offset:8192
    ds_read_b64_tr_b16 a[70:71], v89 offset:8704
    v_mfma_f32_16x16x32_bf16 v[68:71], a[44:47], a[96:99], v[68:71]
    ds_read_b64_tr_b16 a[72:73], v90 offset:8192
    ds_read_b64_tr_b16 a[74:75], v90 offset:8704
    v_mfma_f32_16x16x32_bf16 v[72:75], a[44:47], a[104:107], v[72:75]
    ds_read_b64_tr_b16 a[76:77], v91 offset:8192
    ds_read_b64_tr_b16 a[78:79], v91 offset:8704
    v_mfma_f32_16x16x32_bf16 v[72:75], a[60:63], a[108:111], v[72:75]
    ds_read_b128 a[96:99], v86 offset:12288
    ds_read_b128 a[100:103], v87 offset:12288
    v_mfma_f32_16x16x32_bf16 v[52:55], a[56:59], a[108:111], v[52:55]
    s_waitcnt vmcnt(9)
    ds_read_b64_tr_b16 a[0:1], v88 offset:12288
    ds_read_b64_tr_b16 a[2:3], v88 offset:12800
    v_mfma_f32_16x16x32_bf16 v[52:55], a[40:43], a[104:107], v[52:55]
    ds_read_b64_tr_b16 a[4:5], v89 offset:12288
    ds_read_b64_tr_b16 a[6:7], v89 offset:12800
    v_mfma_f32_16x16x32_bf16 v[32:35], a[36:39], a[104:107], v[32:35]
    ds_read_b64_tr_b16 a[8:9], v90 offset:12288
    ds_read_b64_tr_b16 a[10:11], v90 offset:12800
    v_mfma_f32_16x16x32_bf16 v[32:35], a[52:55], a[108:111], v[32:35]
    ds_read_b64_tr_b16 a[12:13], v91 offset:12288
    ds_read_b64_tr_b16 a[14:15], v91 offset:12800
    v_mfma_f32_16x16x32_bf16 v[12:15], a[48:51], a[108:111], v[12:15]
    ds_read_b128 a[108:111], v87 offset:16384
    v_mfma_f32_16x16x32_bf16 v[12:15], a[32:35], a[104:107], v[12:15]
    ds_read_b128 a[104:107], v86 offset:16384
    v_mfma_f32_16x16x32_bf16 v[16:19], a[32:35], a[112:115], v[16:19]
    v_mfma_f32_16x16x32_bf16 v[16:19], a[48:51], a[116:119], v[16:19]
    v_mfma_f32_16x16x32_bf16 v[36:39], a[52:55], a[116:119], v[36:39]
    v_mfma_f32_16x16x32_bf16 v[36:39], a[36:39], a[112:115], v[36:39]
    v_mfma_f32_16x16x32_bf16 v[56:59], a[40:43], a[112:115], v[56:59]
    v_mfma_f32_16x16x32_bf16 v[56:59], a[56:59], a[116:119], v[56:59]
    v_mfma_f32_16x16x32_bf16 v[76:79], a[60:63], a[116:119], v[76:79]
    v_mfma_f32_16x16x32_bf16 v[76:79], a[44:47], a[112:115], v[76:79]
    s_waitcnt lgkmcnt(0)
    v_mfma_f32_16x16x32_bf16 v[0:3], a[64:67], a[120:123], v[0:3]
    v_mfma_f32_16x16x32_bf16 v[0:3], a[0:3], a[124:127], v[0:3]
    s_nop 2
    v_mfma_f32_16x16x32_bf16 v[20:23], a[4:7], a[124:127], v[20:23]
    s_nop 2
    v_mfma_f32_16x16x32_bf16 v[20:23], a[68:71], a[120:123], v[20:23]
    v_mul_f32 v0, s81, v0
    v_mul_f32 v1, s81, v1
    v_mfma_f32_16x16x32_bf16 v[40:43], a[72:75], a[120:123], v[40:43]
    v_mul_f32 v2, s81, v2
    v_mul_f32 v3, s81, v3
    v_mfma_f32_16x16x32_bf16 v[40:43], a[8:11], a[124:127], v[40:43]
    v_cvt_pk_bf16_f32 v0, v0, v1
    v_cvt_pk_bf16_f32 v1, v2, v3
    v_mfma_f32_16x16x32_bf16 v[60:63], a[12:15], a[124:127], v[60:63]
    v_mul_f32 v20, s81, v20
    v_mul_f32 v21, s81, v21
    v_mfma_f32_16x16x32_bf16 v[60:63], a[76:79], a[120:123], v[60:63]
    ds_write_b64 v198, v[0:1] offset:0
    v_mfma_f32_16x16x32_bf16 v[64:67], a[76:79], a[80:83], v[64:67]
    v_mul_f32 v22, s81, v22
    v_mul_f32 v23, s81, v23
    v_mfma_f32_16x16x32_bf16 v[64:67], a[12:15], a[84:87], v[64:67]
    v_cvt_pk_bf16_f32 v20, v20, v21
    v_mul_f32 v40, s81, v40
    v_mfma_f32_16x16x32_bf16 v[44:47], a[8:11], a[84:87], v[44:47]
    v_cvt_pk_bf16_f32 v21, v22, v23
    v_mul_f32 v41, s81, v41
    v_mfma_f32_16x16x32_bf16 v[44:47], a[72:75], a[80:83], v[44:47]
    ds_write_b64 v198, v[20:21] offset:512
    v_mfma_f32_16x16x32_bf16 v[24:27], a[68:71], a[80:83], v[24:27]
    v_mul_f32 v42, s81, v42
    v_mul_f32 v43, s81, v43
    v_mfma_f32_16x16x32_bf16 v[24:27], a[4:7], a[84:87], v[24:27]
    v_cvt_pk_bf16_f32 v40, v40, v41
    v_mul_f32 v60, s81, v60
    v_mfma_f32_16x16x32_bf16 v[4:7], a[0:3], a[84:87], v[4:7]
    v_cvt_pk_bf16_f32 v41, v42, v43
    v_mul_f32 v61, s81, v61
    v_mfma_f32_16x16x32_bf16 v[4:7], a[64:67], a[80:83], v[4:7]
    ds_write_b64 v198, v[40:41] offset:1024
    v_mfma_f32_16x16x32_bf16 v[8:11], a[64:67], a[88:91], v[8:11]
    v_mul_f32 v62, s81, v62
    v_mul_f32 v63, s81, v63
    v_mfma_f32_16x16x32_bf16 v[8:11], a[0:3], a[92:95], v[8:11]
    v_cvt_pk_bf16_f32 v60, v60, v61
    v_mul_f32 v24, s81, v24
    v_mfma_f32_16x16x32_bf16 v[28:31], a[4:7], a[92:95], v[28:31]
    v_cvt_pk_bf16_f32 v61, v62, v63
    v_mul_f32 v4, s81, v4
    v_mfma_f32_16x16x32_bf16 v[28:31], a[68:71], a[88:91], v[28:31]
    s_barrier
    ds_write_b64 v198, v[60:61] offset:1536
    v_mfma_f32_16x16x32_bf16 v[48:51], a[72:75], a[88:91], v[48:51]
    buffer_load_dwordx4 v250, s[16:19], s74 offen offset:0 nt lds
    v_mfma_f32_16x16x32_bf16 v[48:51], a[8:11], a[92:95], v[48:51]
    v_mul_f32 v5, s81, v5
    v_mul_f32 v6, s81, v6
    v_mfma_f32_16x16x32_bf16 v[68:71], a[12:15], a[92:95], v[68:71]
    v_mul_f32 v7, s81, v7
    v_cvt_pk_bf16_f32 v4, v4, v5
    v_mfma_f32_16x16x32_bf16 v[68:71], a[76:79], a[88:91], v[68:71]
    buffer_load_dwordx4 v251, s[16:19], s74 offen offset:1056 nt lds
    v_mfma_f32_16x16x32_bf16 v[72:75], a[76:79], a[96:99], v[72:75]
    v_cvt_pk_bf16_f32 v5, v6, v7
    v_mul_f32 v25, s81, v25
    v_mfma_f32_16x16x32_bf16 v[72:75], a[12:15], a[100:103], v[72:75]
    ds_write_b64 v198, v[4:5] offset:2048
    v_mfma_f32_16x16x32_bf16 v[52:55], a[8:11], a[100:103], v[52:55]
    v_mul_f32 v26, s81, v26
    v_mul_f32 v27, s81, v27
    v_mfma_f32_16x16x32_bf16 v[52:55], a[72:75], a[96:99], v[52:55]
    v_cvt_pk_bf16_f32 v24, v24, v25
    v_mul_f32 v44, s81, v44
    v_mfma_f32_16x16x32_bf16 v[32:35], a[68:71], a[96:99], v[32:35]
    v_cvt_pk_bf16_f32 v25, v26, v27
    v_mul_f32 v45, s81, v45
    v_mfma_f32_16x16x32_bf16 v[32:35], a[4:7], a[100:103], v[32:35]
    ds_write_b64 v198, v[24:25] offset:2560
    v_mfma_f32_16x16x32_bf16 v[12:15], a[0:3], a[100:103], v[12:15]
    v_mul_f32 v46, s81, v46
    v_mul_f32 v47, s81, v47
    v_mfma_f32_16x16x32_bf16 v[12:15], a[64:67], a[96:99], v[12:15]
    v_cvt_pk_bf16_f32 v44, v44, v45
    v_mul_f32 v64, s81, v64
    v_mfma_f32_16x16x32_bf16 v[16:19], a[64:67], a[104:107], v[16:19]
    v_cvt_pk_bf16_f32 v45, v46, v47
    v_mul_f32 v65, s81, v65
    v_mfma_f32_16x16x32_bf16 v[16:19], a[0:3], a[108:111], v[16:19]
    s_waitcnt vmcnt(6)
    s_barrier
    ds_read_b128 a[128:131], v244 offset:0
    v_mfma_f32_16x16x32_bf16 v[36:39], a[4:7], a[108:111], v[36:39]
    ds_read_b128 a[132:135], v244 offset:64
    ds_read_b128 a[136:139], v244 offset:128
    v_mfma_f32_16x16x32_bf16 v[36:39], a[68:71], a[104:107], v[36:39]
    ds_read_b128 a[140:143], v244 offset:192
    v_mul_f32 v66, s81, v66
    v_mfma_f32_16x16x32_bf16 v[56:59], a[72:75], a[104:107], v[56:59]
    ds_write_b64 v198, v[44:45] offset:3072
    v_mfma_f32_16x16x32_bf16 v[56:59], a[8:11], a[108:111], v[56:59]
    v_mul_f32 v67, s81, v67
    v_cvt_pk_bf16_f32 v64, v64, v65
    v_mfma_f32_16x16x32_bf16 v[76:79], a[12:15], a[108:111], v[76:79]
    ds_read_b128 a[144:147], v244 offset:256
    v_cvt_pk_bf16_f32 v65, v66, v67
    v_mfma_f32_16x16x32_bf16 v[76:79], a[76:79], a[104:107], v[76:79]
    s_waitcnt lgkmcnt(5)
    ds_read_b128 a[148:151], v244 offset:320
    v_pk_mul_f32 v[8:9], v[8:9], s[80:81] op_sel:[0,1] op_sel_hi:[1,1]
    v_pk_mul_f32 v[10:11], v[10:11], s[80:81] op_sel:[0,1] op_sel_hi:[1,1]
    v_cvt_pk_bf16_f32 v8, v8, v9
    v_cvt_pk_bf16_f32 v9, v10, v11
    ds_write_b64 v198, v[64:65] offset:3584
    ds_write_b64 v198, v[8:9] offset:4096
    v_pk_mul_f32 v[28:29], v[28:29], s[80:81] op_sel:[0,1] op_sel_hi:[1,1]
    v_pk_mul_f32 v[30:31], v[30:31], s[80:81] op_sel:[0,1] op_sel_hi:[1,1]
    v_cvt_pk_bf16_f32 v28, v28, v29
    v_cvt_pk_bf16_f32 v29, v30, v31
    v_pk_mul_f32 v[48:49], v[48:49], s[80:81] op_sel:[0,1] op_sel_hi:[1,1]
    v_pk_mul_f32 v[50:51], v[50:51], s[80:81] op_sel:[0,1] op_sel_hi:[1,1]
    v_cvt_pk_bf16_f32 v48, v48, v49
    v_cvt_pk_bf16_f32 v49, v50, v51
    ds_write_b64 v198, v[28:29] offset:4608
    ds_write_b64 v198, v[48:49] offset:5120
    v_pk_mul_f32 v[68:69], v[68:69], s[80:81] op_sel:[0,1] op_sel_hi:[1,1]
    v_pk_mul_f32 v[70:71], v[70:71], s[80:81] op_sel:[0,1] op_sel_hi:[1,1]
    v_cvt_pk_bf16_f32 v68, v68, v69
    v_cvt_pk_bf16_f32 v69, v70, v71
    v_pk_mul_f32 v[12:13], v[12:13], s[80:81] op_sel:[0,1] op_sel_hi:[1,1]
    v_pk_mul_f32 v[14:15], v[14:15], s[80:81] op_sel:[0,1] op_sel_hi:[1,1]
    v_cvt_pk_bf16_f32 v12, v12, v13
    v_cvt_pk_bf16_f32 v13, v14, v15
    ds_write_b64 v198, v[68:69] offset:5632
    ds_write_b64 v198, v[12:13] offset:6144
    v_pk_mul_f32 v[32:33], v[32:33], s[80:81] op_sel:[0,1] op_sel_hi:[1,1]
    v_pk_mul_f32 v[34:35], v[34:35], s[80:81] op_sel:[0,1] op_sel_hi:[1,1]
    v_cvt_pk_bf16_f32 v32, v32, v33
    v_cvt_pk_bf16_f32 v33, v34, v35
    v_pk_mul_f32 v[52:53], v[52:53], s[80:81] op_sel:[0,1] op_sel_hi:[1,1]
    v_pk_mul_f32 v[54:55], v[54:55], s[80:81] op_sel:[0,1] op_sel_hi:[1,1]
    v_cvt_pk_bf16_f32 v52, v52, v53
    v_cvt_pk_bf16_f32 v53, v54, v55
    ds_write_b64 v198, v[32:33] offset:6656
    ds_write_b64 v198, v[52:53] offset:7168
    v_pk_mul_f32 v[72:73], v[72:73], s[80:81] op_sel:[0,1] op_sel_hi:[1,1]
    v_pk_mul_f32 v[74:75], v[74:75], s[80:81] op_sel:[0,1] op_sel_hi:[1,1]
    v_cvt_pk_bf16_f32 v72, v72, v73
    v_cvt_pk_bf16_f32 v73, v74, v75
    ds_write_b64 v198, v[72:73] offset:7680
    buffer_load_dwordx4 v252, s[16:19], s74 offen offset:2112 nt lds
    ds_read_b128 a[152:155], v244 offset:384
    ds_read_b128 a[156:159], v244 offset:448
    ds_read_b128 a[160:163], v245 offset:0
    ds_read_b128 a[164:167], v245 offset:64
    ds_read_b128 a[168:171], v245 offset:128
    v_mul_f32 v16, s81, v16
    v_mul_f32 v17, s81, v17
    v_mul_f32 v18, s81, v18
    buffer_load_dwordx4 v253, s[16:19], s74 offen offset:3168 nt lds
    s_waitcnt lgkmcnt(5)
    s_barrier
    ds_read_b128 a[208:211], v197 offset:0
    s_add_u32 m0, s73, 33792
    s_add_u32 s74, s40, 16384
    buffer_load_dwordx4 v250, s[12:15], s72 offen offset:0 nt lds
    ds_read_b128 a[212:215], v197 offset:1024
    ds_read_b128 a[216:219], v197 offset:16384
    ds_read_b128 a[220:223], v197 offset:17408
    ds_read_b128 a[236:239], v197 offset:19456
    ds_read_b128 a[232:235], v197 offset:18432
    ds_read_b128 a[228:231], v197 offset:3072
    ds_read_b128 a[224:227], v197 offset:2048
    v_mul_f32 v19, s81, v19
    buffer_load_dwordx4 v251, s[12:15], s72 offen offset:1056 nt lds
    v_cvt_pk_bf16_f32 v16, v16, v17
    v_cvt_pk_bf16_f32 v17, v18, v19
    ds_write_b64 v198, v[16:17] offset:8192
    buffer_load_dwordx4 v252, s[12:15], s72 offen offset:2112 nt lds
    v_mul_f32 v36, s81, v36
    v_mul_f32 v37, s81, v37
    v_mul_f32 v38, s81, v38
    v_mul_f32 v39, s81, v39
    s_waitcnt lgkmcnt(8)
    v_mfma_f32_16x16x32_bf16 v[96:99], a[128:131], a[208:211], v[200:203]
    s_waitcnt lgkmcnt(7)
    v_cvt_pk_bf16_f32 v36, v36, v37
    v_mul_f32 v56, s81, v56
    v_mfma_f32_16x16x32_bf16 v[96:99], a[132:135], a[212:215], v[96:99]
    s_waitcnt lgkmcnt(6)
    v_cvt_pk_bf16_f32 v37, v38, v39
    v_mul_f32 v57, s81, v57
    v_mfma_f32_16x16x32_bf16 v[96:99], a[136:139], a[216:219], v[96:99]
    s_waitcnt lgkmcnt(5)
    ds_write_b64 v198, v[36:37] offset:8704
    v_mfma_f32_16x16x32_bf16 v[96:99], a[140:143], a[220:223], v[96:99]
    s_waitcnt lgkmcnt(5)
    v_mul_f32 v58, s81, v58
    v_mul_f32 v59, s81, v59
    v_mfma_f32_16x16x32_bf16 v[104:107], a[140:143], a[236:239], v[204:207]
    s_waitcnt lgkmcnt(4)
    v_cvt_pk_bf16_f32 v56, v56, v57
    v_mul_f32 v76, s81, v76
    v_mfma_f32_16x16x32_bf16 v[104:107], a[136:139], a[232:235], v[104:107]
    s_waitcnt lgkmcnt(1)
    v_cvt_pk_bf16_f32 v57, v58, v59
    v_mul_f32 v77, s81, v77
    v_mfma_f32_16x16x32_bf16 v[104:107], a[132:135], a[228:231], v[104:107]
    buffer_load_dwordx4 v253, s[12:15], s72 offen offset:3168 nt lds
    v_mfma_f32_16x16x32_bf16 v[104:107], a[128:131], a[224:227], v[104:107]
    s_add_u32 m0, s73, 67584
    ds_write_b64 v198, v[56:57] offset:9216
    v_mfma_f32_16x16x32_bf16 v[108:111], a[144:147], a[224:227], v[204:207]
    s_add_u32 s72, s40, 49152
    v_mul_f32 v78, s81, v78
    v_mul_f32 v79, s81, v79
    v_mfma_f32_16x16x32_bf16 v[108:111], a[148:151], a[228:231], v[108:111]
    ds_read_b128 a[172:175], v245 offset:192
    v_cvt_pk_bf16_f32 v76, v76, v77
    v_mfma_f32_16x16x32_bf16 v[108:111], a[152:155], a[232:235], v[108:111]
    ds_read_b128 a[176:179], v245 offset:448
    v_cvt_pk_bf16_f32 v77, v78, v79
    v_mfma_f32_16x16x32_bf16 v[108:111], a[156:159], a[236:239], v[108:111]
    ds_write_b64 v198, v[76:77] offset:9728
    v_mfma_f32_16x16x32_bf16 v[100:103], a[156:159], a[220:223], v[200:203]
    ds_read_b128 a[180:183], v245 offset:384
    ds_read_b128 a[184:187], v245 offset:320
    v_mfma_f32_16x16x32_bf16 v[100:103], a[152:155], a[216:219], v[100:103]
    s_waitcnt vmcnt(8)
    ds_read_b128 a[188:191], v245 offset:256
    v_mov_b32 v198, s67
    v_mfma_f32_16x16x32_bf16 v[100:103], a[148:151], a[212:215], v[100:103]
    s_lshl_b32 s67, s80, 12
    v_exp_f32 v96, v96
    v_mfma_f32_16x16x32_bf16 v[100:103], a[144:147], a[208:211], v[100:103]
    s_waitcnt lgkmcnt(3)
    s_barrier
    ds_read_b128 a[240:243], v196 offset:0
    v_mfma_f32_16x16x32_bf16 v[112:115], a[160:163], a[208:211], v[200:203]
    s_sub_u32 s67, s47, s67
    ds_read_b128 a[244:247], v196 offset:1024
    ds_read_b128 a[248:251], v196 offset:16384
    v_mfma_f32_16x16x32_bf16 v[112:115], a[164:167], a[212:215], v[112:115]
    ds_read_b128 a[252:255], v196 offset:17408
    v_mfma_f32_16x16x32_bf16 v[112:115], a[168:171], a[216:219], v[112:115]
    buffer_load_dwordx4 v250, s[16:19], s74 offen offset:0 nt lds
    v_mfma_f32_16x16x32_bf16 v[112:115], a[172:175], a[220:223], v[112:115]
    ds_read_b128 a[192:195], v244 offset:16896
    ds_read_b128 a[196:199], v244 offset:16960
    v_mfma_f32_16x16x32_bf16 v[120:123], a[172:175], a[236:239], v[204:207]
    v_exp_f32 v97, v97
    v_mfma_f32_16x16x32_bf16 v[120:123], a[168:171], a[232:235], v[120:123]
    ds_read_b128 a[200:203], v244 offset:17024
    ds_read_b128 a[204:207], v244 offset:17088
    v_mfma_f32_16x16x32_bf16 v[120:123], a[164:167], a[228:231], v[120:123]
    ds_read_b128 a[128:131], v244 offset:17344
    v_cvt_pk_bf16_f32 v152, v96, v97
    v_mfma_f32_16x16x32_bf16 v[120:123], a[160:163], a[224:227], v[120:123]
    s_waitcnt lgkmcnt(7)
    v_exp_f32 v98, v98
    v_mfma_f32_16x16x32_bf16 v[128:131], a[160:163], a[240:243], v[208:211]
    ds_read_b128 a[132:135], v244 offset:17280
    ds_read_b128 a[136:139], v244 offset:17216
    v_mfma_f32_16x16x32_bf16 v[128:131], a[164:167], a[244:247], v[128:131]
    s_waitcnt lgkmcnt(7)
    v_exp_f32 v99, v99
    v_mfma_f32_16x16x32_bf16 v[128:131], a[168:171], a[248:251], v[128:131]
    buffer_load_dwordx4 v251, s[16:19], s74 offen offset:1056 nt lds
    v_mfma_f32_16x16x32_bf16 v[128:131], a[172:175], a[252:255], v[128:131]
    ds_read_b128 a[140:143], v244 offset:17152
    v_cvt_pk_bf16_f32 v153, v98, v99
    v_mfma_f32_16x16x32_bf16 v[132:135], a[176:179], a[252:255], v[208:211]
    v_exp_f32 v100, v100
    v_mfma_f32_16x16x32_bf16 v[132:135], a[180:183], a[248:251], v[132:135]
    v_exp_f32 v101, v101
    v_mfma_f32_16x16x32_bf16 v[132:135], a[184:187], a[244:247], v[132:135]
    ds_read_b128 a[144:147], v245 offset:16896
    v_cvt_pk_bf16_f32 v154, v100, v101
    v_mfma_f32_16x16x32_bf16 v[132:135], a[188:191], a[240:243], v[132:135]
    v_exp_f32 v102, v102
    v_mfma_f32_16x16x32_bf16 v[124:127], a[188:191], a[224:227], v[204:207]
    v_exp_f32 v103, v103
    v_mfma_f32_16x16x32_bf16 v[124:127], a[184:187], a[228:231], v[124:127]
    buffer_load_dwordx4 v252, s[16:19], s74 offen offset:2112 nt lds
    v_mfma_f32_16x16x32_bf16 v[124:127], a[180:183], a[232:235], v[124:127]
    ds_read_b128 a[148:151], v245 offset:16960
    v_cvt_pk_bf16_f32 v155, v102, v103
    v_mfma_f32_16x16x32_bf16 v[124:127], a[176:179], a[236:239], v[124:127]
    ds_read_b128 a[152:155], v245 offset:17024
    ds_read_b128 a[156:159], v245 offset:17088
    v_mfma_f32_16x16x32_bf16 v[116:119], a[176:179], a[220:223], v[200:203]
    v_exp_f32 v104, v104
    v_mfma_f32_16x16x32_bf16 v[116:119], a[180:183], a[216:219], v[116:119]
    v_exp_f32 v105, v105
    v_mfma_f32_16x16x32_bf16 v[116:119], a[184:187], a[212:215], v[116:119]
    ds_read_b128 a[160:163], v245 offset:17152
    v_cvt_pk_bf16_f32 v156, v104, v105
    v_mfma_f32_16x16x32_bf16 v[116:119], a[188:191], a[208:211], v[116:119]
    s_waitcnt lgkmcnt(4)
    v_exp_f32 v106, v106
    v_mfma_f32_16x16x32_bf16 v[136:139], a[192:195], a[208:211], v[200:203]
    buffer_load_dwordx4 v253, s[16:19], s74 offen offset:3168 nt lds
    v_mfma_f32_16x16x32_bf16 v[136:139], a[196:199], a[212:215], v[136:139]
    s_add_u32 m0, s73, 0
    v_exp_f32 v107, v107
    v_mfma_f32_16x16x32_bf16 v[136:139], a[200:203], a[216:219], v[136:139]
    s_add_u32 s74, s40, 32768
    ds_read_b128 a[164:167], v245 offset:17216
    v_cvt_pk_bf16_f32 v157, v106, v107
    v_mfma_f32_16x16x32_bf16 v[136:139], a[204:207], a[220:223], v[136:139]
    ds_read_b128 a[168:171], v245 offset:17280
    ds_read_b128 a[172:175], v245 offset:17344
    v_mfma_f32_16x16x32_bf16 v[144:147], a[204:207], a[236:239], v[204:207]
    v_exp_f32 v112, v112
    v_mfma_f32_16x16x32_bf16 v[144:147], a[200:203], a[232:235], v[144:147]
    v_exp_f32 v113, v113
    v_mfma_f32_16x16x32_bf16 v[144:147], a[196:199], a[228:231], v[144:147]
    v_exp_f32 v114, v114
    v_mfma_f32_16x16x32_bf16 v[144:147], a[192:195], a[224:227], v[144:147]
    v_exp_f32 v115, v115
    v_mfma_f32_16x16x32_bf16 v[96:99], a[192:195], a[240:243], v[208:211]
    v_cvt_pk_bf16_f32 v160, v112, v113
    v_cvt_pk_bf16_f32 v161, v114, v115
    v_mfma_f32_16x16x32_bf16 v[96:99], a[196:199], a[244:247], v[96:99]
    s_waitcnt vmcnt(8)
    v_exp_f32 v116, v116
    v_mfma_f32_16x16x32_bf16 v[96:99], a[200:203], a[248:251], v[96:99]
    v_exp_f32 v117, v117
    v_mfma_f32_16x16x32_bf16 v[96:99], a[204:207], a[252:255], v[96:99]
    v_exp_f32 v118, v118
    v_mfma_f32_16x16x32_bf16 v[100:103], a[128:131], a[252:255], v[208:211]
    v_exp_f32 v119, v119
    v_mfma_f32_16x16x32_bf16 v[100:103], a[132:135], a[248:251], v[100:103]
    v_cvt_pk_bf16_f32 v162, v116, v117
    v_cvt_pk_bf16_f32 v163, v118, v119
    v_mfma_f32_16x16x32_bf16 v[100:103], a[136:139], a[244:247], v[100:103]
    v_exp_f32 v108, v108
    v_mfma_f32_16x16x32_bf16 v[100:103], a[140:143], a[240:243], v[100:103]
    v_exp_f32 v109, v109
    v_mfma_f32_16x16x32_bf16 v[148:151], a[140:143], a[224:227], v[204:207]
    v_exp_f32 v110, v110
    v_mfma_f32_16x16x32_bf16 v[148:151], a[136:139], a[228:231], v[148:151]
    v_exp_f32 v111, v111
    v_mfma_f32_16x16x32_bf16 v[148:151], a[132:135], a[232:235], v[148:151]
    v_cvt_pk_bf16_f32 v158, v108, v109
    v_cvt_pk_bf16_f32 v159, v110, v111
    v_mfma_f32_16x16x32_bf16 v[148:151], a[128:131], a[236:239], v[148:151]
    v_exp_f32 v120, v120
    v_mfma_f32_16x16x32_bf16 v[140:143], a[128:131], a[220:223], v[200:203]
    v_exp_f32 v121, v121
    v_mfma_f32_16x16x32_bf16 v[140:143], a[132:135], a[216:219], v[140:143]
    v_exp_f32 v122, v122
    v_mfma_f32_16x16x32_bf16 v[140:143], a[136:139], a[212:215], v[140:143]
    v_exp_f32 v123, v123
    v_mfma_f32_16x16x32_bf16 v[140:143], a[140:143], a[208:211], v[140:143]
    v_cvt_pk_bf16_f32 v164, v120, v121
    v_cvt_pk_bf16_f32 v165, v122, v123
    v_mfma_f32_16x16x32_bf16 v[104:107], a[144:147], a[208:211], v[200:203]
    s_waitcnt lgkmcnt(0)
    v_exp_f32 v124, v124
    v_mfma_f32_16x16x32_bf16 v[104:107], a[148:151], a[212:215], v[104:107]
    v_exp_f32 v125, v125
    v_mfma_f32_16x16x32_bf16 v[104:107], a[152:155], a[216:219], v[104:107]
    v_exp_f32 v126, v126
    v_mfma_f32_16x16x32_bf16 v[104:107], a[156:159], a[220:223], v[104:107]
    v_exp_f32 v127, v127
    v_mfma_f32_16x16x32_bf16 v[112:115], a[156:159], a[236:239], v[204:207]
    v_cvt_pk_bf16_f32 v166, v124, v125
    v_cvt_pk_bf16_f32 v167, v126, v127
    v_mfma_f32_16x16x32_bf16 v[112:115], a[152:155], a[232:235], v[112:115]
    v_exp_f32 v128, v128
    v_mfma_f32_16x16x32_bf16 v[112:115], a[148:151], a[228:231], v[112:115]
    s_barrier
    ds_read_b64_tr_b16 a[176:177], v242 offset:0
    ds_read_b64_tr_b16 a[178:179], v242 offset:256
    v_mfma_f32_16x16x32_bf16 v[112:115], a[144:147], a[224:227], v[112:115]
    ds_read_b64_tr_b16 a[180:181], v240 offset:0
    ds_read_b64_tr_b16 a[182:183], v240 offset:256
    v_mfma_f32_16x16x32_bf16 v[116:119], a[160:163], a[224:227], v[204:207]
    buffer_load_dwordx4 v250, s[12:15], s72 offen offset:0 nt lds
    v_mfma_f32_16x16x32_bf16 v[116:119], a[164:167], a[228:231], v[116:119]
    ds_read_b64_tr_b16 a[184:185], v242 offset:32
    ds_read_b64_tr_b16 a[186:187], v242 offset:288
    v_mfma_f32_16x16x32_bf16 v[116:119], a[168:171], a[232:235], v[116:119]
    ds_read_b64_tr_b16 a[188:189], v240 offset:32
    ds_read_b64_tr_b16 a[190:191], v240 offset:288
    v_mfma_f32_16x16x32_bf16 v[116:119], a[172:175], a[236:239], v[116:119]
    ds_read_b64_tr_b16 a[192:193], v242 offset:64
    ds_read_b64_tr_b16 a[194:195], v242 offset:320
    v_mfma_f32_16x16x32_bf16 v[108:111], a[172:175], a[220:223], v[200:203]
    v_exp_f32 v129, v129
    v_mfma_f32_16x16x32_bf16 v[108:111], a[168:171], a[216:219], v[108:111]
    ds_read_b64_tr_b16 a[196:197], v240 offset:64
    v_cvt_pk_bf16_f32 v168, v128, v129
    v_mfma_f32_16x16x32_bf16 v[108:111], a[164:167], a[212:215], v[108:111]
    v_exp_f32 v130, v130
    v_mfma_f32_16x16x32_bf16 v[108:111], a[160:163], a[208:211], v[108:111]
    s_waitcnt lgkmcnt(6)
    v_exp_f32 v131, v131
    v_mfma_f32_16x16x32_bf16 v[0:3], a[176:179], v[160:163], 0
    buffer_load_dwordx4 v251, s[12:15], s72 offen offset:1056 nt lds
    v_mfma_f32_16x16x32_bf16 v[0:3], a[180:183], v[152:155], v[0:3]
    ds_read_b64_tr_b16 a[198:199], v240 offset:320
    v_cvt_pk_bf16_f32 v169, v130, v131
    v_mfma_f32_16x16x32_bf16 v[32:35], a[180:183], v[156:159], 0
    v_exp_f32 v132, v132
    v_mfma_f32_16x16x32_bf16 v[32:35], a[176:179], v[164:167], v[32:35]
    v_exp_f32 v133, v133
    v_exp_f32 v134, v134
    v_cvt_pk_bf16_f32 v170, v132, v133
    v_exp_f32 v135, v135
    ds_read_b64_tr_b16 a[200:201], v242 offset:96
    v_cvt_pk_bf16_f32 v171, v134, v135
    s_nop 1
    v_mfma_f32_16x16x32_bf16 v[64:67], a[176:179], v[168:171], 0
    s_waitcnt lgkmcnt(2)
    ds_read_b64_tr_b16 a[202:203], v242 offset:352
    ds_read_b64_tr_b16 a[204:205], v240 offset:96
    v_mfma_f32_16x16x32_bf16 v[68:71], a[184:187], v[168:171], 0
    buffer_load_dwordx4 v252, s[12:15], s72 offen offset:2112 nt lds
    v_mfma_f32_16x16x32_bf16 v[36:39], a[184:187], v[164:167], 0
    ds_read_b64_tr_b16 a[206:207], v240 offset:352
    ds_read_b64_tr_b16 a[128:129], v243 offset:0
    v_mfma_f32_16x16x32_bf16 v[36:39], a[188:191], v[156:159], v[36:39]
    ds_read_b64_tr_b16 a[130:131], v243 offset:256
    ds_read_b64_tr_b16 a[132:133], v241 offset:0
    v_mfma_f32_16x16x32_bf16 v[4:7], a[188:191], v[152:155], 0
    ds_read_b64_tr_b16 a[134:135], v241 offset:256
    ds_read_b64_tr_b16 a[136:137], v243 offset:32
    v_mfma_f32_16x16x32_bf16 v[4:7], a[184:187], v[160:163], v[4:7]
    ds_read_b64_tr_b16 a[138:139], v243 offset:288
    ds_read_b64_tr_b16 a[140:141], v241 offset:32
    v_mfma_f32_16x16x32_bf16 v[8:11], a[192:195], v[160:163], 0
    s_waitcnt lgkmcnt(9)
    ds_read_b64_tr_b16 a[142:143], v241 offset:288
    ds_read_b64_tr_b16 a[144:145], v243 offset:64
    v_mfma_f32_16x16x32_bf16 v[8:11], a[196:199], v[152:155], v[8:11]
    ds_read_b64_tr_b16 a[146:147], v243 offset:320
    ds_read_b64_tr_b16 a[148:149], v241 offset:64
    v_mfma_f32_16x16x32_bf16 v[40:43], a[196:199], v[156:159], 0
    buffer_load_dwordx4 v253, s[12:15], s72 offen offset:3168 nt lds
    v_mfma_f32_16x16x32_bf16 v[40:43], a[192:195], v[164:167], v[40:43]
    s_add_u32 m0, s73, 84480
    ds_read_b64_tr_b16 a[150:151], v241 offset:320
    ds_read_b64_tr_b16 a[152:153], v243 offset:96
    v_mfma_f32_16x16x32_bf16 v[72:75], a[192:195], v[168:171], 0
    s_add_u32 s72, s40, 65536
    ds_read_b64_tr_b16 a[154:155], v243 offset:352
    ds_read_b64_tr_b16 a[156:157], v241 offset:96
    v_mfma_f32_16x16x32_bf16 v[76:79], a[200:203], v[168:171], 0
    v_exp_f32 v136, v136
    v_mfma_f32_16x16x32_bf16 v[44:47], a[200:203], v[164:167], 0
    s_waitcnt lgkmcnt(7)
    v_exp_f32 v137, v137
    v_mfma_f32_16x16x32_bf16 v[44:47], a[204:207], v[156:159], v[44:47]
    s_waitcnt vmcnt(4)
    ds_read_b64_tr_b16 a[158:159], v241 offset:352
    v_cvt_pk_bf16_f32 v172, v136, v137
    v_mfma_f32_16x16x32_bf16 v[12:15], a[204:207], v[152:155], 0
    s_barrier
    ds_read_b128 a[160:163], v244 offset:33792
    ds_read_b128 a[164:167], v244 offset:33856
    v_mfma_f32_16x16x32_bf16 v[12:15], a[200:203], v[160:163], v[12:15]
    buffer_load_dwordx4 v250, s[16:19], s74 offen offset:0 nt lds
    v_mfma_f32_16x16x32_bf16 v[16:19], a[128:131], v[160:163], 0
    ds_read_b128 a[168:171], v244 offset:33920
    ds_read_b128 a[172:175], v244 offset:33984
    v_mfma_f32_16x16x32_bf16 v[16:19], a[132:135], v[152:155], v[16:19]
    v_exp_f32 v138, v138
    v_mfma_f32_16x16x32_bf16 v[48:51], a[132:135], v[156:159], 0
    buffer_load_dwordx4 v251, s[16:19], s74 offen offset:1056 nt lds
    v_mfma_f32_16x16x32_bf16 v[48:51], a[128:131], v[164:167], v[48:51]
    ds_read_b128 a[176:179], v244 offset:34240
    ds_read_b128 a[180:183], v244 offset:34176
    v_mfma_f32_16x16x32_bf16 v[80:83], a[128:131], v[168:171], 0
    v_exp_f32 v139, v139
    v_mfma_f32_16x16x32_bf16 v[84:87], a[136:139], v[168:171], 0
    buffer_load_dwordx4 v252, s[16:19], s74 offen offset:2112 nt lds
    v_mfma_f32_16x16x32_bf16 v[52:55], a[136:139], v[164:167], 0
    ds_read_b128 a[184:187], v244 offset:34112
    ds_read_b128 a[188:191], v244 offset:34048
    v_mfma_f32_16x16x32_bf16 v[52:55], a[140:143], v[156:159], v[52:55]
    ds_read_b128 a[192:195], v245 offset:33792
    v_cvt_pk_bf16_f32 v173, v138, v139
    v_mfma_f32_16x16x32_bf16 v[20:23], a[140:143], v[152:155], 0
    buffer_load_dwordx4 v253, s[16:19], s74 offen offset:3168 nt lds
    v_mfma_f32_16x16x32_bf16 v[20:23], a[136:139], v[160:163], v[20:23]
    s_waitcnt lgkmcnt(5)
    v_exp_f32 v140, v140
    v_mfma_f32_16x16x32_bf16 v[24:27], a[144:147], v[160:163], 0
    s_add_u32 m0, s73, 16896
    v_exp_f32 v141, v141
    v_mfma_f32_16x16x32_bf16 v[24:27], a[148:151], v[152:155], v[24:27]
    buffer_load_dwordx4 v250, s[12:15], s72 offen offset:0 nt lds
    v_mfma_f32_16x16x32_bf16 v[56:59], a[148:151], v[156:159], 0
    s_add_u32 s74, s40, 49152
    ds_read_b128 a[196:199], v245 offset:33856
    v_cvt_pk_bf16_f32 v174, v140, v141
    v_mfma_f32_16x16x32_bf16 v[56:59], a[144:147], v[164:167], v[56:59]
    v_exp_f32 v142, v142
    v_mfma_f32_16x16x32_bf16 v[88:91], a[144:147], v[168:171], 0
    v_exp_f32 v143, v143
    v_mfma_f32_16x16x32_bf16 v[92:95], a[152:155], v[168:171], 0
    ds_read_b128 a[200:203], v245 offset:33920
    v_cvt_pk_bf16_f32 v175, v142, v143
    v_mfma_f32_16x16x32_bf16 v[60:63], a[152:155], v[164:167], 0
    ds_read_b128 a[204:207], v245 offset:33984
    ds_read_b128 a[128:131], v245 offset:34048
    v_mfma_f32_16x16x32_bf16 v[60:63], a[156:159], v[156:159], v[60:63]
    v_exp_f32 v144, v144
    v_mfma_f32_16x16x32_bf16 v[28:31], a[156:159], v[152:155], 0
    buffer_load_dwordx4 v251, s[12:15], s72 offen offset:1056 nt lds
    v_mfma_f32_16x16x32_bf16 v[28:31], a[152:155], v[160:163], v[28:31]
    v_exp_f32 v145, v145
    v_mfma_f32_16x16x32_bf16 v[212:215], v[224:227], v[152:155], 0
    ds_read_b128 a[132:135], v245 offset:34112
    v_cvt_pk_bf16_f32 v176, v144, v145
    v_mfma_f32_16x16x32_bf16 v[212:215], v[224:227], v[160:163], v[212:215]
    v_exp_f32 v146, v146
    v_mfma_f32_16x16x32_bf16 v[216:219], v[224:227], v[156:159], 0
    v_exp_f32 v147, v147
    v_mfma_f32_16x16x32_bf16 v[216:219], v[224:227], v[164:167], v[216:219]
    ds_read_b128 a[136:139], v245 offset:34176
    v_cvt_pk_bf16_f32 v177, v146, v147
    v_mfma_f32_16x16x32_bf16 v[220:223], v[224:227], v[168:171], 0
    ds_read_b128 a[140:143], v245 offset:34240
    ds_read_b64_tr_b16 a[144:145], v240 offset:16896
    v_mfma_f32_16x16x32_bf16 v[120:123], a[160:163], a[208:211], v[200:203]
    buffer_load_dwordx4 v252, s[12:15], s72 offen offset:2112 nt lds
    v_mfma_f32_16x16x32_bf16 v[120:123], a[164:167], a[212:215], v[120:123]
    v_exp_f32 v96, v96
    v_mfma_f32_16x16x32_bf16 v[120:123], a[168:171], a[216:219], v[120:123]
    v_exp_f32 v97, v97
    v_mfma_f32_16x16x32_bf16 v[120:123], a[172:175], a[220:223], v[120:123]
    ds_read_b64_tr_b16 a[146:147], v240 offset:17152
    v_cvt_pk_bf16_f32 v180, v96, v97
    v_mfma_f32_16x16x32_bf16 v[128:131], a[172:175], a[236:239], v[204:207]
    v_exp_f32 v98, v98
    v_mfma_f32_16x16x32_bf16 v[128:131], a[168:171], a[232:235], v[128:131]
    v_exp_f32 v99, v99
    v_mfma_f32_16x16x32_bf16 v[128:131], a[164:167], a[228:231], v[128:131]
    ds_read_b64_tr_b16 a[148:149], v242 offset:16896
    v_cvt_pk_bf16_f32 v181, v98, v99
    v_mfma_f32_16x16x32_bf16 v[128:131], a[160:163], a[224:227], v[128:131]
    buffer_load_dwordx4 v253, s[12:15], s72 offen offset:3168 nt lds
    v_mfma_f32_16x16x32_bf16 v[136:139], a[160:163], a[240:243], v[208:211]
    s_add_u32 m0, s73, 101376
    v_exp_f32 v100, v100
    v_mfma_f32_16x16x32_bf16 v[136:139], a[164:167], a[244:247], v[136:139]
    s_add_u32 s72, s40, 81920
    v_exp_f32 v101, v101
    v_mfma_f32_16x16x32_bf16 v[136:139], a[168:171], a[248:251], v[136:139]
    ds_read_b64_tr_b16 a[150:151], v242 offset:17152
    v_cvt_pk_bf16_f32 v182, v100, v101
    v_mfma_f32_16x16x32_bf16 v[136:139], a[172:175], a[252:255], v[136:139]
    s_waitcnt lgkmcnt(2)
    v_exp_f32 v102, v102
    v_mfma_f32_16x16x32_bf16 v[140:143], a[176:179], a[252:255], v[208:211]
    v_exp_f32 v103, v103
    v_mfma_f32_16x16x32_bf16 v[140:143], a[180:183], a[248:251], v[140:143]
    ds_read_b64_tr_b16 a[152:153], v240 offset:16928
    v_cvt_pk_bf16_f32 v183, v102, v103
    v_mfma_f32_16x16x32_bf16 v[140:143], a[184:187], a[244:247], v[140:143]
    v_exp_f32 v148, v148
    v_mfma_f32_16x16x32_bf16 v[140:143], a[188:191], a[240:243], v[140:143]
    v_exp_f32 v149, v149
    v_mfma_f32_16x16x32_bf16 v[132:135], a[188:191], a[224:227], v[204:207]
    ds_read_b64_tr_b16 a[154:155], v240 offset:17184
    v_cvt_pk_bf16_f32 v178, v148, v149
    v_mfma_f32_16x16x32_bf16 v[132:135], a[184:187], a[228:231], v[132:135]
    v_exp_f32 v150, v150
    v_mfma_f32_16x16x32_bf16 v[132:135], a[180:183], a[232:235], v[132:135]
    v_exp_f32 v151, v151
    v_mfma_f32_16x16x32_bf16 v[132:135], a[176:179], a[236:239], v[132:135]
    ds_read_b64_tr_b16 a[156:157], v242 offset:16928
    v_cvt_pk_bf16_f32 v179, v150, v151
    v_mfma_f32_16x16x32_bf16 v[124:127], a[176:179], a[220:223], v[200:203]
    ds_read_b64_tr_b16 a[158:159], v242 offset:17184
    ds_read_b64_tr_b16 a[160:161], v240 offset:16960
    v_mfma_f32_16x16x32_bf16 v[124:127], a[180:183], a[216:219], v[124:127]
    v_exp_f32 v104, v104
    v_mfma_f32_16x16x32_bf16 v[124:127], a[184:187], a[212:215], v[124:127]
    v_exp_f32 v105, v105
    v_mfma_f32_16x16x32_bf16 v[124:127], a[188:191], a[208:211], v[124:127]
    ds_read_b64_tr_b16 a[162:163], v240 offset:17216
    v_cvt_pk_bf16_f32 v184, v104, v105
    v_mfma_f32_16x16x32_bf16 v[144:147], a[192:195], a[208:211], v[200:203]
    v_exp_f32 v106, v106
    v_mfma_f32_16x16x32_bf16 v[144:147], a[196:199], a[212:215], v[144:147]
    v_exp_f32 v107, v107
    v_mfma_f32_16x16x32_bf16 v[144:147], a[200:203], a[216:219], v[144:147]
    ds_read_b64_tr_b16 a[164:165], v242 offset:16960
    v_cvt_pk_bf16_f32 v185, v106, v107
    v_mfma_f32_16x16x32_bf16 v[144:147], a[204:207], a[220:223], v[144:147]
    v_exp_f32 v108, v108
    v_mfma_f32_16x16x32_bf16 v[96:99], a[204:207], a[236:239], v[204:207]
    v_exp_f32 v109, v109
    v_mfma_f32_16x16x32_bf16 v[96:99], a[200:203], a[232:235], v[96:99]
    ds_read_b64_tr_b16 a[166:167], v242 offset:17216
    v_cvt_pk_bf16_f32 v186, v108, v109
    v_mfma_f32_16x16x32_bf16 v[96:99], a[196:199], a[228:231], v[96:99]
    v_exp_f32 v110, v110
    v_mfma_f32_16x16x32_bf16 v[96:99], a[192:195], a[224:227], v[96:99]
    v_exp_f32 v111, v111
    v_mfma_f32_16x16x32_bf16 v[100:103], a[128:131], a[224:227], v[204:207]
    ds_read_b64_tr_b16 a[168:169], v240 offset:16992
    v_cvt_pk_bf16_f32 v187, v110, v111
    v_mfma_f32_16x16x32_bf16 v[100:103], a[132:135], a[228:231], v[100:103]
    v_exp_f32 v112, v112
    v_mfma_f32_16x16x32_bf16 v[100:103], a[136:139], a[232:235], v[100:103]
    v_exp_f32 v113, v113
    v_mfma_f32_16x16x32_bf16 v[100:103], a[140:143], a[236:239], v[100:103]
    ds_read_b64_tr_b16 a[170:171], v240 offset:17248
    v_cvt_pk_bf16_f32 v188, v112, v113
    v_mfma_f32_16x16x32_bf16 v[148:151], a[140:143], a[220:223], v[200:203]
    v_exp_f32 v114, v114
    v_mfma_f32_16x16x32_bf16 v[148:151], a[136:139], a[216:219], v[148:151]
    v_exp_f32 v115, v115
    v_mfma_f32_16x16x32_bf16 v[148:151], a[132:135], a[212:215], v[148:151]
    ds_read_b64_tr_b16 a[172:173], v242 offset:16992
    v_cvt_pk_bf16_f32 v189, v114, v115
    v_mfma_f32_16x16x32_bf16 v[148:151], a[128:131], a[208:211], v[148:151]
    v_exp_f32 v116, v116
    v_mfma_f32_16x16x32_bf16 v[0:3], a[144:147], v[172:175], v[0:3]
    s_waitcnt lgkmcnt(2)
    v_exp_f32 v117, v117
    v_mfma_f32_16x16x32_bf16 v[0:3], a[148:151], v[184:187], v[0:3]
    ds_read_b64_tr_b16 a[174:175], v242 offset:17248
    v_cvt_pk_bf16_f32 v190, v116, v117
    v_exp_f32 v118, v118
    v_exp_f32 v119, v119
    ds_read_b64_tr_b16 a[176:177], v241 offset:16896
    v_cvt_pk_bf16_f32 v191, v118, v119
    s_nop 1
    v_mfma_f32_16x16x32_bf16 v[32:35], a[148:151], v[188:191], v[32:35]
    ds_read_b64_tr_b16 a[178:179], v241 offset:17152
    ds_read_b64_tr_b16 a[180:181], v243 offset:16896
    v_mfma_f32_16x16x32_bf16 v[32:35], a[144:147], v[176:179], v[32:35]
    ds_read_b64_tr_b16 a[182:183], v243 offset:17152
    ds_read_b64_tr_b16 a[184:185], v241 offset:16928
    v_mfma_f32_16x16x32_bf16 v[64:67], a[144:147], v[180:183], v[64:67]
    ds_read_b64_tr_b16 a[186:187], v241 offset:17184
    ds_read_b64_tr_b16 a[188:189], v243 offset:16928
    v_mfma_f32_16x16x32_bf16 v[68:71], a[152:155], v[180:183], v[68:71]
    ds_read_b64_tr_b16 a[190:191], v243 offset:17184
    ds_read_b64_tr_b16 a[192:193], v241 offset:16960
    v_mfma_f32_16x16x32_bf16 v[36:39], a[152:155], v[176:179], v[36:39]
    ds_read_b64_tr_b16 a[194:195], v241 offset:17216
    ds_read_b64_tr_b16 a[196:197], v243 offset:16960
    v_mfma_f32_16x16x32_bf16 v[36:39], a[156:159], v[188:191], v[36:39]
    s_waitcnt vmcnt(4)
    ds_read_b64_tr_b16 a[198:199], v243 offset:17216
    ds_read_b64_tr_b16 a[200:201], v241 offset:16992
    v_mfma_f32_16x16x32_bf16 v[4:7], a[156:159], v[184:187], v[4:7]
    s_barrier
    ds_read_b64_tr_b16 a[202:203], v241 offset:17248
    ds_read_b64_tr_b16 a[204:205], v243 offset:16992
    v_mfma_f32_16x16x32_bf16 v[4:7], a[152:155], v[172:175], v[4:7]
    buffer_load_dwordx4 v250, s[16:19], s74 offen offset:0 nt lds
    v_mfma_f32_16x16x32_bf16 v[8:11], a[160:163], v[172:175], v[8:11]
    ds_read_b64_tr_b16 a[206:207], v243 offset:17248
    ds_read_b128 a[128:131], v244 offset:0
    v_mfma_f32_16x16x32_bf16 v[8:11], a[164:167], v[184:187], v[8:11]
    ds_read_b128 a[132:135], v244 offset:64
    ds_read_b128 a[136:139], v244 offset:128
    v_mfma_f32_16x16x32_bf16 v[40:43], a[164:167], v[188:191], v[40:43]
    buffer_load_dwordx4 v251, s[16:19], s74 offen offset:1056 nt lds
    v_mfma_f32_16x16x32_bf16 v[40:43], a[160:163], v[176:179], v[40:43]
    ds_read_b128 a[140:143], v244 offset:192
    ds_read_b128 a[144:147], v244 offset:448
    v_mfma_f32_16x16x32_bf16 v[72:75], a[160:163], v[180:183], v[72:75]
    s_waitcnt lgkmcnt(7)
    v_exp_f32 v120, v120
    v_mfma_f32_16x16x32_bf16 v[76:79], a[168:171], v[180:183], v[76:79]
    buffer_load_dwordx4 v252, s[16:19], s74 offen offset:2112 nt lds
    v_mfma_f32_16x16x32_bf16 v[44:47], a[168:171], v[176:179], v[44:47]
    ds_read_b128 a[148:151], v244 offset:384
    ds_read_b128 a[152:155], v244 offset:320
    v_mfma_f32_16x16x32_bf16 v[44:47], a[172:175], v[188:191], v[44:47]
    v_exp_f32 v121, v121
    v_mfma_f32_16x16x32_bf16 v[12:15], a[172:175], v[184:187], v[12:15]
    buffer_load_dwordx4 v253, s[16:19], s74 offen offset:3168 nt lds
    v_mfma_f32_16x16x32_bf16 v[12:15], a[168:171], v[172:175], v[12:15]
    s_add_u32 m0, s77, 118272
    ds_read_b128 a[156:159], v244 offset:256
    v_cvt_pk_bf16_f32 v152, v120, v121
    v_mfma_f32_16x16x32_bf16 v[16:19], a[176:179], v[172:175], v[16:19]
    buffer_load_dwordx4 v246, s[20:23], s52 offen offset:0 lds
    v_mfma_f32_16x16x32_bf16 v[16:19], a[180:183], v[184:187], v[16:19]
    s_add_u32 s74, s40, 65536
    v_exp_f32 v122, v122
    v_mfma_f32_16x16x32_bf16 v[48:51], a[180:183], v[188:191], v[48:51]
    v_exp_f32 v123, v123
    v_mfma_f32_16x16x32_bf16 v[48:51], a[176:179], v[176:179], v[48:51]
    ds_read_b128 a[160:163], v245 offset:0
    v_cvt_pk_bf16_f32 v153, v122, v123
    v_mfma_f32_16x16x32_bf16 v[80:83], a[176:179], v[180:183], v[80:83]
    v_exp_f32 v124, v124
    v_mfma_f32_16x16x32_bf16 v[84:87], a[184:187], v[180:183], v[84:87]
    v_exp_f32 v125, v125
    v_mfma_f32_16x16x32_bf16 v[52:55], a[184:187], v[176:179], v[52:55]
    ds_read_b128 a[164:167], v245 offset:64
    v_cvt_pk_bf16_f32 v154, v124, v125
    v_mfma_f32_16x16x32_bf16 v[52:55], a[188:191], v[188:191], v[52:55]
    buffer_load_dwordx4 v247, s[20:23], s52 offen offset:1024 lds
    v_mfma_f32_16x16x32_bf16 v[20:23], a[188:191], v[184:187], v[20:23]
    v_exp_f32 v126, v126
    v_mfma_f32_16x16x32_bf16 v[20:23], a[184:187], v[172:175], v[20:23]
    v_exp_f32 v127, v127
    v_mfma_f32_16x16x32_bf16 v[24:27], a[192:195], v[172:175], v[24:27]
    ds_read_b128 a[168:171], v245 offset:128
    v_cvt_pk_bf16_f32 v155, v126, v127
    v_mfma_f32_16x16x32_bf16 v[24:27], a[196:199], v[184:187], v[24:27]
    ds_read_b128 a[172:175], v245 offset:192
    ds_read_b128 a[176:179], v245 offset:256
    v_mfma_f32_16x16x32_bf16 v[56:59], a[196:199], v[188:191], v[56:59]
    v_exp_f32 v128, v128
    v_mfma_f32_16x16x32_bf16 v[56:59], a[192:195], v[176:179], v[56:59]
    v_exp_f32 v129, v129
    v_mfma_f32_16x16x32_bf16 v[88:91], a[192:195], v[180:183], v[88:91]
    buffer_load_dwordx4 v248, s[20:23], s52 offen offset:2048 lds
    v_mfma_f32_16x16x32_bf16 v[92:95], a[200:203], v[180:183], v[92:95]
    ds_read_b128 a[180:183], v245 offset:320
    v_cvt_pk_bf16_f32 v156, v128, v129
    v_mfma_f32_16x16x32_bf16 v[60:63], a[200:203], v[176:179], v[60:63]
    s_waitcnt lgkmcnt(4)
    v_exp_f32 v130, v130
    v_mfma_f32_16x16x32_bf16 v[60:63], a[204:207], v[188:191], v[60:63]
    v_exp_f32 v131, v131
    v_mfma_f32_16x16x32_bf16 v[28:31], a[204:207], v[184:187], v[28:31]
    ds_read_b128 a[184:187], v245 offset:384
    v_cvt_pk_bf16_f32 v157, v130, v131
    v_mfma_f32_16x16x32_bf16 v[28:31], a[200:203], v[172:175], v[28:31]
    ds_read_b128 a[188:191], v245 offset:448
    ds_read_b64_tr_b16 a[192:193], v240 offset:33792
    v_mfma_f32_16x16x32_bf16 v[212:215], v[224:227], v[172:175], v[212:215]
    v_exp_f32 v136, v136
    v_mfma_f32_16x16x32_bf16 v[212:215], v[224:227], v[184:187], v[212:215]
    buffer_load_dwordx4 v249, s[20:23], s52 offen offset:3072 lds
    v_mfma_f32_16x16x32_bf16 v[216:219], v[224:227], v[176:179], v[216:219]
    s_add_u32 m0, s73, 33792
    v_exp_f32 v137, v137
    v_mfma_f32_16x16x32_bf16 v[216:219], v[224:227], v[188:191], v[216:219]
    buffer_load_dwordx4 v250, s[12:15], s72 offen offset:0 nt lds
    v_mfma_f32_16x16x32_bf16 v[220:223], v[224:227], v[180:183], v[220:223]
    s_add_u32 s52, s52, 32768
    ds_read_b64_tr_b16 a[194:195], v240 offset:34048
    v_cvt_pk_bf16_f32 v160, v136, v137
    v_mfma_f32_16x16x32_bf16 v[104:107], a[128:131], a[208:211], v[200:203]
    v_exp_f32 v138, v138
    v_mfma_f32_16x16x32_bf16 v[104:107], a[132:135], a[212:215], v[104:107]
    v_exp_f32 v139, v139
    v_mfma_f32_16x16x32_bf16 v[104:107], a[136:139], a[216:219], v[104:107]
    ds_read_b64_tr_b16 a[196:197], v242 offset:33792
    v_cvt_pk_bf16_f32 v161, v138, v139
    v_mfma_f32_16x16x32_bf16 v[104:107], a[140:143], a[220:223], v[104:107]
    v_exp_f32 v140, v140
    v_mfma_f32_16x16x32_bf16 v[112:115], a[140:143], a[236:239], v[204:207]
    v_exp_f32 v141, v141
    v_mfma_f32_16x16x32_bf16 v[112:115], a[136:139], a[232:235], v[112:115]
    buffer_load_dwordx4 v251, s[12:15], s72 offen offset:1056 nt lds
    v_mfma_f32_16x16x32_bf16 v[112:115], a[132:135], a[228:231], v[112:115]
    ds_read_b64_tr_b16 a[198:199], v242 offset:34048
    v_cvt_pk_bf16_f32 v162, v140, v141
    v_mfma_f32_16x16x32_bf16 v[112:115], a[128:131], a[224:227], v[112:115]
    v_exp_f32 v142, v142
    v_mfma_f32_16x16x32_bf16 v[120:123], a[128:131], a[240:243], v[208:211]
    v_exp_f32 v143, v143
    v_mfma_f32_16x16x32_bf16 v[120:123], a[132:135], a[244:247], v[120:123]
    ds_read_b64_tr_b16 a[200:201], v240 offset:33824
    v_cvt_pk_bf16_f32 v163, v142, v143
    v_mfma_f32_16x16x32_bf16 v[120:123], a[136:139], a[248:251], v[120:123]
    v_exp_f32 v132, v132
    v_mfma_f32_16x16x32_bf16 v[120:123], a[140:143], a[252:255], v[120:123]
    v_exp_f32 v133, v133
    v_mfma_f32_16x16x32_bf16 v[124:127], a[144:147], a[252:255], v[208:211]
    buffer_load_dwordx4 v252, s[12:15], s72 offen offset:2112 nt lds
    v_mfma_f32_16x16x32_bf16 v[124:127], a[148:151], a[248:251], v[124:127]
    ds_read_b64_tr_b16 a[202:203], v240 offset:34080
    v_cvt_pk_bf16_f32 v158, v132, v133
    v_mfma_f32_16x16x32_bf16 v[124:127], a[152:155], a[244:247], v[124:127]
    v_exp_f32 v134, v134
    v_mfma_f32_16x16x32_bf16 v[124:127], a[156:159], a[240:243], v[124:127]
    v_exp_f32 v135, v135
    v_mfma_f32_16x16x32_bf16 v[116:119], a[156:159], a[224:227], v[204:207]
    ds_read_b64_tr_b16 a[204:205], v242 offset:33824
    v_cvt_pk_bf16_f32 v159, v134, v135
    v_mfma_f32_16x16x32_bf16 v[116:119], a[152:155], a[228:231], v[116:119]
    ds_read_b64_tr_b16 a[206:207], v242 offset:34080
    ds_read_b64_tr_b16 a[128:129], v240 offset:33856
    v_mfma_f32_16x16x32_bf16 v[116:119], a[148:151], a[232:235], v[116:119]
    v_exp_f32 v144, v144
    v_mfma_f32_16x16x32_bf16 v[116:119], a[144:147], a[236:239], v[116:119]
    buffer_load_dwordx4 v253, s[12:15], s72 offen offset:3168 nt lds
    v_mfma_f32_16x16x32_bf16 v[108:111], a[144:147], a[220:223], v[200:203]
    s_add_u32 m0, s73, 50688
    v_exp_f32 v145, v145
    v_mfma_f32_16x16x32_bf16 v[108:111], a[148:151], a[216:219], v[108:111]
    s_add_u32 s72, s40, 98304
    ds_read_b64_tr_b16 a[130:131], v240 offset:34112
    v_cvt_pk_bf16_f32 v164, v144, v145
    v_mfma_f32_16x16x32_bf16 v[108:111], a[152:155], a[212:215], v[108:111]
    v_exp_f32 v146, v146
    v_mfma_f32_16x16x32_bf16 v[108:111], a[156:159], a[208:211], v[108:111]
    v_exp_f32 v147, v147
    v_mfma_f32_16x16x32_bf16 v[128:131], a[160:163], a[208:211], v[200:203]
    ds_read_b64_tr_b16 a[132:133], v242 offset:33856
    v_cvt_pk_bf16_f32 v165, v146, v147
    v_mfma_f32_16x16x32_bf16 v[128:131], a[164:167], a[212:215], v[128:131]
    s_waitcnt lgkmcnt(2)
    v_exp_f32 v148, v148
    v_mfma_f32_16x16x32_bf16 v[128:131], a[168:171], a[216:219], v[128:131]
    v_exp_f32 v149, v149
    v_mfma_f32_16x16x32_bf16 v[128:131], a[172:175], a[220:223], v[128:131]
    ds_read_b64_tr_b16 a[134:135], v242 offset:34112
    v_cvt_pk_bf16_f32 v166, v148, v149
    v_mfma_f32_16x16x32_bf16 v[136:139], a[172:175], a[236:239], v[204:207]
    v_exp_f32 v150, v150
    v_mfma_f32_16x16x32_bf16 v[136:139], a[168:171], a[232:235], v[136:139]
    v_exp_f32 v151, v151
    v_mfma_f32_16x16x32_bf16 v[136:139], a[164:167], a[228:231], v[136:139]
    ds_read_b64_tr_b16 a[136:137], v240 offset:33888
    v_cvt_pk_bf16_f32 v167, v150, v151
    v_mfma_f32_16x16x32_bf16 v[136:139], a[160:163], a[224:227], v[136:139]
    v_exp_f32 v96, v96
    v_mfma_f32_16x16x32_bf16 v[140:143], a[176:179], a[224:227], v[204:207]
    v_exp_f32 v97, v97
    v_mfma_f32_16x16x32_bf16 v[140:143], a[180:183], a[228:231], v[140:143]
    ds_read_b64_tr_b16 a[138:139], v240 offset:34144
    v_cvt_pk_bf16_f32 v168, v96, v97
    v_mfma_f32_16x16x32_bf16 v[140:143], a[184:187], a[232:235], v[140:143]
    v_exp_f32 v98, v98
    v_mfma_f32_16x16x32_bf16 v[140:143], a[188:191], a[236:239], v[140:143]
    v_exp_f32 v99, v99
    v_mfma_f32_16x16x32_bf16 v[132:135], a[188:191], a[220:223], v[200:203]
    ds_read_b64_tr_b16 a[140:141], v242 offset:33888
    v_cvt_pk_bf16_f32 v169, v98, v99
    v_mfma_f32_16x16x32_bf16 v[132:135], a[184:187], a[216:219], v[132:135]
    v_exp_f32 v100, v100
    v_mfma_f32_16x16x32_bf16 v[132:135], a[180:183], a[212:215], v[132:135]
    v_exp_f32 v101, v101
    v_mfma_f32_16x16x32_bf16 v[132:135], a[176:179], a[208:211], v[132:135]
    ds_read_b64_tr_b16 a[142:143], v242 offset:34144
    v_cvt_pk_bf16_f32 v170, v100, v101
    v_mfma_f32_16x16x32_bf16 v[0:3], a[192:195], v[152:155], v[0:3]
    v_exp_f32 v102, v102
    v_mfma_f32_16x16x32_bf16 v[0:3], a[196:199], v[164:167], v[0:3]
    v_exp_f32 v103, v103
    ds_read_b64_tr_b16 a[144:145], v241 offset:33792
    v_cvt_pk_bf16_f32 v171, v102, v103
    s_nop 1
    v_mfma_f32_16x16x32_bf16 v[32:35], a[196:199], v[168:171], v[32:35]
    ds_read_b64_tr_b16 a[146:147], v241 offset:34048
    ds_read_b64_tr_b16 a[148:149], v243 offset:33792
    v_mfma_f32_16x16x32_bf16 v[32:35], a[192:195], v[156:159], v[32:35]
    ds_read_b64_tr_b16 a[150:151], v243 offset:34048
    ds_read_b64_tr_b16 a[152:153], v241 offset:33824
    v_mfma_f32_16x16x32_bf16 v[64:67], a[192:195], v[160:163], v[64:67]
    ds_read_b64_tr_b16 a[154:155], v241 offset:34080
    ds_read_b64_tr_b16 a[156:157], v243 offset:33824
    v_mfma_f32_16x16x32_bf16 v[68:71], a[200:203], v[160:163], v[68:71]
    ds_read_b64_tr_b16 a[158:159], v243 offset:34080
    ds_read_b64_tr_b16 a[160:161], v241 offset:33856
    v_mfma_f32_16x16x32_bf16 v[36:39], a[200:203], v[156:159], v[36:39]
    s_waitcnt vmcnt(8)
    ds_read_b64_tr_b16 a[162:163], v241 offset:34112
    ds_read_b64_tr_b16 a[164:165], v243 offset:33856
    v_mfma_f32_16x16x32_bf16 v[36:39], a[204:207], v[168:171], v[36:39]
    s_barrier
    ds_read_b64_tr_b16 a[166:167], v243 offset:34112
    ds_read_b64_tr_b16 a[168:169], v241 offset:33888
    v_mfma_f32_16x16x32_bf16 v[4:7], a[204:207], v[164:167], v[4:7]
    buffer_load_dwordx4 v250, s[16:19], s74 offen offset:0 nt lds
    v_mfma_f32_16x16x32_bf16 v[4:7], a[200:203], v[152:155], v[4:7]
    s_waitcnt lgkmcnt(8)
    ds_read_b64_tr_b16 a[170:171], v241 offset:34144
    ds_read_b64_tr_b16 a[172:173], v243 offset:33888
    v_mfma_f32_16x16x32_bf16 v[8:11], a[128:131], v[152:155], v[8:11]
    ds_read_b64_tr_b16 a[174:175], v243 offset:34144
    ds_read_b128 a[176:179], v244 offset:16896
    v_mfma_f32_16x16x32_bf16 v[8:11], a[132:135], v[164:167], v[8:11]
    buffer_load_dwordx4 v251, s[16:19], s74 offen offset:1056 nt lds
    v_mfma_f32_16x16x32_bf16 v[40:43], a[132:135], v[168:171], v[40:43]
    ds_read_b128 a[180:183], v244 offset:16960
    ds_read_b128 a[184:187], v244 offset:17024
    v_mfma_f32_16x16x32_bf16 v[40:43], a[128:131], v[156:159], v[40:43]
    v_exp_f32 v104, v104
    v_mfma_f32_16x16x32_bf16 v[72:75], a[128:131], v[160:163], v[72:75]
    buffer_load_dwordx4 v252, s[16:19], s74 offen offset:2112 nt lds
    v_mfma_f32_16x16x32_bf16 v[76:79], a[136:139], v[160:163], v[76:79]
    ds_read_b128 a[188:191], v244 offset:17088
    ds_read_b128 a[192:195], v244 offset:17344
    v_mfma_f32_16x16x32_bf16 v[44:47], a[136:139], v[156:159], v[44:47]
    v_exp_f32 v105, v105
    v_mfma_f32_16x16x32_bf16 v[44:47], a[140:143], v[168:171], v[44:47]
    buffer_load_dwordx4 v253, s[16:19], s74 offen offset:3168 nt lds
    v_mfma_f32_16x16x32_bf16 v[12:15], a[140:143], v[164:167], v[12:15]
    s_add_u32 m0, s73, 0
    ds_read_b128 a[196:199], v244 offset:17280
    ds_read_b128 a[200:203], v244 offset:17216
    v_mfma_f32_16x16x32_bf16 v[12:15], a[136:139], v[152:155], v[12:15]
    buffer_load_dwordx4 v250, s[12:15], s72 offen offset:0 nt lds
    v_mfma_f32_16x16x32_bf16 v[16:19], a[144:147], v[152:155], v[16:19]
    s_add_u32 s74, s40, 81920
    ds_read_b128 a[204:207], v244 offset:17152
    v_cvt_pk_bf16_f32 v172, v104, v105
    v_mfma_f32_16x16x32_bf16 v[16:19], a[148:151], v[164:167], v[16:19]
    v_exp_f32 v106, v106
    v_mfma_f32_16x16x32_bf16 v[48:51], a[148:151], v[168:171], v[48:51]
    v_exp_f32 v107, v107
    v_mfma_f32_16x16x32_bf16 v[48:51], a[144:147], v[156:159], v[48:51]
    ds_read_b128 a[128:131], v245 offset:16896
    v_cvt_pk_bf16_f32 v173, v106, v107
    v_mfma_f32_16x16x32_bf16 v[80:83], a[144:147], v[160:163], v[80:83]
    s_waitcnt lgkmcnt(4)
    v_exp_f32 v108, v108
    v_mfma_f32_16x16x32_bf16 v[84:87], a[152:155], v[160:163], v[84:87]
    v_exp_f32 v109, v109
    v_mfma_f32_16x16x32_bf16 v[52:55], a[152:155], v[156:159], v[52:55]
    buffer_load_dwordx4 v251, s[12:15], s72 offen offset:1056 nt lds
    v_mfma_f32_16x16x32_bf16 v[52:55], a[156:159], v[168:171], v[52:55]
    ds_read_b128 a[132:135], v245 offset:16960
    v_cvt_pk_bf16_f32 v174, v108, v109
    v_mfma_f32_16x16x32_bf16 v[20:23], a[156:159], v[164:167], v[20:23]
    v_exp_f32 v110, v110
    v_mfma_f32_16x16x32_bf16 v[20:23], a[152:155], v[152:155], v[20:23]
    v_exp_f32 v111, v111
    v_mfma_f32_16x16x32_bf16 v[24:27], a[160:163], v[152:155], v[24:27]
    ds_read_b128 a[136:139], v245 offset:17024
    v_cvt_pk_bf16_f32 v175, v110, v111
    v_mfma_f32_16x16x32_bf16 v[24:27], a[164:167], v[164:167], v[24:27]
    ds_read_b128 a[140:143], v245 offset:17088
    ds_read_b128 a[144:147], v245 offset:17152
    v_mfma_f32_16x16x32_bf16 v[56:59], a[164:167], v[168:171], v[56:59]
    v_exp_f32 v112, v112
    v_mfma_f32_16x16x32_bf16 v[56:59], a[160:163], v[156:159], v[56:59]
    buffer_load_dwordx4 v252, s[12:15], s72 offen offset:2112 nt lds
    v_mfma_f32_16x16x32_bf16 v[88:91], a[160:163], v[160:163], v[88:91]
    v_exp_f32 v113, v113
    v_mfma_f32_16x16x32_bf16 v[92:95], a[168:171], v[160:163], v[92:95]
    ds_read_b128 a[148:151], v245 offset:17216
    v_cvt_pk_bf16_f32 v176, v112, v113
    v_mfma_f32_16x16x32_bf16 v[60:63], a[168:171], v[156:159], v[60:63]
    v_exp_f32 v114, v114
    v_mfma_f32_16x16x32_bf16 v[60:63], a[172:175], v[168:171], v[60:63]
    v_exp_f32 v115, v115
    v_mfma_f32_16x16x32_bf16 v[28:31], a[172:175], v[164:167], v[28:31]
    ds_read_b128 a[152:155], v245 offset:17280
    v_cvt_pk_bf16_f32 v177, v114, v115
    v_mfma_f32_16x16x32_bf16 v[28:31], a[168:171], v[152:155], v[28:31]
    ds_read_b128 a[156:159], v245 offset:17344
    ds_read_b64_tr_b16 a[160:161], v240 offset:50688
    v_mfma_f32_16x16x32_bf16 v[212:215], v[224:227], v[152:155], v[212:215]
    buffer_load_dwordx4 v253, s[12:15], s72 offen offset:3168 nt lds
    v_mfma_f32_16x16x32_bf16 v[212:215], v[224:227], v[164:167], v[212:215]
    s_add_u32 m0, s73, 67584
    v_exp_f32 v120, v120
    v_mfma_f32_16x16x32_bf16 v[216:219], v[224:227], v[156:159], v[216:219]
    s_add_u32 s72, s40, 114688
    v_exp_f32 v121, v121
    v_mfma_f32_16x16x32_bf16 v[216:219], v[224:227], v[168:171], v[216:219]
    ds_read_b64_tr_b16 a[162:163], v240 offset:50944
    v_cvt_pk_bf16_f32 v180, v120, v121
    v_mfma_f32_16x16x32_bf16 v[220:223], v[224:227], v[160:163], v[220:223]
    v_exp_f32 v122, v122
    v_mfma_f32_16x16x32_bf16 v[144:147], a[176:179], a[208:211], v[200:203]
    v_exp_f32 v123, v123
    v_mfma_f32_16x16x32_bf16 v[144:147], a[180:183], a[212:215], v[144:147]
    ds_read_b64_tr_b16 a[164:165], v242 offset:50688
    v_cvt_pk_bf16_f32 v181, v122, v123
    v_mfma_f32_16x16x32_bf16 v[144:147], a[184:187], a[216:219], v[144:147]
    v_exp_f32 v124, v124
    v_mfma_f32_16x16x32_bf16 v[144:147], a[188:191], a[220:223], v[144:147]
    v_exp_f32 v125, v125
    v_mfma_f32_16x16x32_bf16 v[96:99], a[188:191], a[236:239], v[204:207]
    ds_read_b64_tr_b16 a[166:167], v242 offset:50944
    v_cvt_pk_bf16_f32 v182, v124, v125
    v_mfma_f32_16x16x32_bf16 v[96:99], a[184:187], a[232:235], v[96:99]
    v_exp_f32 v126, v126
    v_mfma_f32_16x16x32_bf16 v[96:99], a[180:183], a[228:231], v[96:99]
    v_exp_f32 v127, v127
    v_mfma_f32_16x16x32_bf16 v[96:99], a[176:179], a[224:227], v[96:99]
    ds_read_b64_tr_b16 a[168:169], v240 offset:50720
    v_cvt_pk_bf16_f32 v183, v126, v127
    v_mfma_f32_16x16x32_bf16 v[104:107], a[176:179], a[240:243], v[208:211]
    v_exp_f32 v116, v116
    v_mfma_f32_16x16x32_bf16 v[104:107], a[180:183], a[244:247], v[104:107]
    v_exp_f32 v117, v117
    v_mfma_f32_16x16x32_bf16 v[104:107], a[184:187], a[248:251], v[104:107]
    ds_read_b64_tr_b16 a[170:171], v240 offset:50976
    v_cvt_pk_bf16_f32 v178, v116, v117
    v_mfma_f32_16x16x32_bf16 v[104:107], a[188:191], a[252:255], v[104:107]
    v_exp_f32 v118, v118
    v_mfma_f32_16x16x32_bf16 v[108:111], a[192:195], a[252:255], v[208:211]
    s_waitcnt lgkmcnt(2)
    v_exp_f32 v119, v119
    v_mfma_f32_16x16x32_bf16 v[108:111], a[196:199], a[248:251], v[108:111]
    ds_read_b64_tr_b16 a[172:173], v242 offset:50720
    v_cvt_pk_bf16_f32 v179, v118, v119
    v_mfma_f32_16x16x32_bf16 v[108:111], a[200:203], a[244:247], v[108:111]
    ds_read_b64_tr_b16 a[174:175], v242 offset:50976
    ds_read_b64_tr_b16 a[176:177], v240 offset:50752
    v_mfma_f32_16x16x32_bf16 v[108:111], a[204:207], a[240:243], v[108:111]
    v_exp_f32 v128, v128
    v_mfma_f32_16x16x32_bf16 v[100:103], a[204:207], a[224:227], v[204:207]
    s_waitcnt vmcnt(12)
    v_exp_f32 v129, v129
    v_mfma_f32_16x16x32_bf16 v[100:103], a[200:203], a[228:231], v[100:103]
    ds_read_b64_tr_b16 a[178:179], v240 offset:51008
    v_cvt_pk_bf16_f32 v184, v128, v129
    v_mfma_f32_16x16x32_bf16 v[100:103], a[196:199], a[232:235], v[100:103]
    v_exp_f32 v130, v130
    v_mfma_f32_16x16x32_bf16 v[100:103], a[192:195], a[236:239], v[100:103]
    v_exp_f32 v131, v131
    v_mfma_f32_16x16x32_bf16 v[148:151], a[192:195], a[220:223], v[200:203]
    ds_read_b64_tr_b16 a[180:181], v242 offset:50752
    v_cvt_pk_bf16_f32 v185, v130, v131
    v_mfma_f32_16x16x32_bf16 v[148:151], a[196:199], a[216:219], v[148:151]
    v_exp_f32 v132, v132
    v_mfma_f32_16x16x32_bf16 v[148:151], a[200:203], a[212:215], v[148:151]
    v_exp_f32 v133, v133
    v_mfma_f32_16x16x32_bf16 v[148:151], a[204:207], a[208:211], v[148:151]
    ds_read_b64_tr_b16 a[182:183], v242 offset:51008
    v_cvt_pk_bf16_f32 v186, v132, v133
    v_mfma_f32_16x16x32_bf16 v[112:115], a[128:131], a[208:211], v[200:203]
    v_exp_f32 v134, v134
    v_mfma_f32_16x16x32_bf16 v[112:115], a[132:135], a[212:215], v[112:115]
    v_exp_f32 v135, v135
    v_mfma_f32_16x16x32_bf16 v[112:115], a[136:139], a[216:219], v[112:115]
    ds_read_b64_tr_b16 a[184:185], v240 offset:50784
    v_cvt_pk_bf16_f32 v187, v134, v135
    v_mfma_f32_16x16x32_bf16 v[112:115], a[140:143], a[220:223], v[112:115]
    v_exp_f32 v136, v136
    v_mfma_f32_16x16x32_bf16 v[120:123], a[140:143], a[236:239], v[204:207]
    v_exp_f32 v137, v137
    v_mfma_f32_16x16x32_bf16 v[120:123], a[136:139], a[232:235], v[120:123]
    ds_read_b64_tr_b16 a[186:187], v240 offset:51040
    v_cvt_pk_bf16_f32 v188, v136, v137
    v_mfma_f32_16x16x32_bf16 v[120:123], a[132:135], a[228:231], v[120:123]
    v_exp_f32 v138, v138
    v_mfma_f32_16x16x32_bf16 v[120:123], a[128:131], a[224:227], v[120:123]
    v_exp_f32 v139, v139
    v_mfma_f32_16x16x32_bf16 v[124:127], a[144:147], a[224:227], v[204:207]
    ds_read_b64_tr_b16 a[188:189], v242 offset:50784
    v_cvt_pk_bf16_f32 v189, v138, v139
    v_mfma_f32_16x16x32_bf16 v[124:127], a[148:151], a[228:231], v[124:127]
    v_exp_f32 v140, v140
    v_mfma_f32_16x16x32_bf16 v[124:127], a[152:155], a[232:235], v[124:127]
    v_exp_f32 v141, v141
    v_mfma_f32_16x16x32_bf16 v[124:127], a[156:159], a[236:239], v[124:127]
    ds_read_b64_tr_b16 a[190:191], v242 offset:51040
    v_cvt_pk_bf16_f32 v190, v140, v141
    v_mfma_f32_16x16x32_bf16 v[116:119], a[156:159], a[220:223], v[200:203]
    v_exp_f32 v142, v142
    v_mfma_f32_16x16x32_bf16 v[116:119], a[152:155], a[216:219], v[116:119]
    v_exp_f32 v143, v143
    v_mfma_f32_16x16x32_bf16 v[116:119], a[148:151], a[212:215], v[116:119]
    ds_read_b64_tr_b16 a[192:193], v241 offset:50688
    v_cvt_pk_bf16_f32 v191, v142, v143
    v_mfma_f32_16x16x32_bf16 v[116:119], a[144:147], a[208:211], v[116:119]
    ds_read_b64_tr_b16 a[194:195], v241 offset:50944
    ds_read_b64_tr_b16 a[196:197], v243 offset:50688
    v_mfma_f32_16x16x32_bf16 v[0:3], a[160:163], v[172:175], v[0:3]
    ds_read_b64_tr_b16 a[198:199], v243 offset:50944
    ds_read_b64_tr_b16 a[200:201], v241 offset:50720
    v_mfma_f32_16x16x32_bf16 v[0:3], a[164:167], v[184:187], v[0:3]
    ds_read_b64_tr_b16 a[202:203], v241 offset:50976
    ds_read_b64_tr_b16 a[204:205], v243 offset:50720
    v_mfma_f32_16x16x32_bf16 v[32:35], a[164:167], v[188:191], v[32:35]
    ds_read_b64_tr_b16 a[206:207], v243 offset:50976
    ds_read_b64_tr_b16 a[128:129], v241 offset:50752
    v_mfma_f32_16x16x32_bf16 v[32:35], a[160:163], v[176:179], v[32:35]
    ds_read_b64_tr_b16 a[130:131], v241 offset:51008
    ds_read_b64_tr_b16 a[132:133], v243 offset:50752
    v_mfma_f32_16x16x32_bf16 v[64:67], a[160:163], v[180:183], v[64:67]
    s_waitcnt lgkmcnt(10)
    ds_read_b64_tr_b16 a[134:135], v243 offset:51008
    ds_read_b64_tr_b16 a[136:137], v241 offset:50784
    v_mfma_f32_16x16x32_bf16 v[68:71], a[168:171], v[180:183], v[68:71]
    ds_read_b64_tr_b16 a[138:139], v241 offset:51040
    ds_read_b64_tr_b16 a[0:1], v231 offset:0
    v_mfma_f32_16x16x32_bf16 v[36:39], a[168:171], v[176:179], v[36:39]
    s_waitcnt vmcnt(4)
    ds_read_b64_tr_b16 a[2:3], v231 offset:2048
    ds_read_b64_tr_b16 a[4:5], v232 offset:0
    v_mfma_f32_16x16x32_bf16 v[36:39], a[172:175], v[188:191], v[36:39]
    s_barrier
    ds_read_b64_tr_b16 a[6:7], v232 offset:2048
    ds_read_b64_tr_b16 a[8:9], v233 offset:0
    v_mfma_f32_16x16x32_bf16 v[4:7], a[172:175], v[184:187], v[4:7]
    buffer_load_dwordx4 v250, s[16:19], s74 offen offset:0 nt lds
    v_mfma_f32_16x16x32_bf16 v[4:7], a[168:171], v[172:175], v[4:7]
    ds_read_b64_tr_b16 a[10:11], v233 offset:2048
    ds_read_b64_tr_b16 a[12:13], v234 offset:0
    v_mfma_f32_16x16x32_bf16 v[8:11], a[176:179], v[172:175], v[8:11]
    ds_read_b64_tr_b16 a[14:15], v234 offset:2048
    ds_read_b64_tr_b16 a[140:141], v243 offset:50784
    v_mfma_f32_16x16x32_bf16 v[8:11], a[180:183], v[184:187], v[8:11]
    buffer_load_dwordx4 v251, s[16:19], s74 offen offset:1056 nt lds
    v_mfma_f32_16x16x32_bf16 v[40:43], a[180:183], v[188:191], v[40:43]
    ds_read_b64_tr_b16 a[142:143], v243 offset:51040
    ds_read_b128 a[144:147], v244 offset:33792
    v_mfma_f32_16x16x32_bf16 v[40:43], a[176:179], v[176:179], v[40:43]
    ds_read_b128 a[148:151], v244 offset:33856
    ds_read_b128 a[152:155], v244 offset:33920
    v_mfma_f32_16x16x32_bf16 v[72:75], a[176:179], v[180:183], v[72:75]
    buffer_load_dwordx4 v252, s[16:19], s74 offen offset:2112 nt lds
    v_mfma_f32_16x16x32_bf16 v[76:79], a[184:187], v[180:183], v[76:79]
    ds_read_b128 a[156:159], v244 offset:33984
    ds_read_b128 a[160:163], v244 offset:34240
    v_mfma_f32_16x16x32_bf16 v[44:47], a[184:187], v[176:179], v[44:47]
    v_exp_f32 v144, v144
    v_mfma_f32_16x16x32_bf16 v[44:47], a[188:191], v[188:191], v[44:47]
    buffer_load_dwordx4 v253, s[16:19], s74 offen offset:3168 nt lds
    v_mfma_f32_16x16x32_bf16 v[12:15], a[188:191], v[184:187], v[12:15]
    s_add_u32 m0, s77, 134656
    ds_read_b128 a[164:167], v244 offset:34176
    ds_read_b128 a[168:171], v244 offset:34112
    v_mfma_f32_16x16x32_bf16 v[12:15], a[184:187], v[172:175], v[12:15]
    s_waitcnt lgkmcnt(6)
    v_exp_f32 v145, v145
    v_mfma_f32_16x16x32_bf16 v[16:19], a[192:195], v[172:175], v[16:19]
    buffer_load_dwordx4 v246, s[20:23], s52 offen offset:0 lds
    v_mfma_f32_16x16x32_bf16 v[16:19], a[196:199], v[184:187], v[16:19]
    s_add_u32 s74, s40, 98304
    ds_read_b128 a[172:175], v244 offset:34048
    v_cvt_pk_bf16_f32 v152, v144, v145
    v_mfma_f32_16x16x32_bf16 v[48:51], a[196:199], v[188:191], v[48:51]
    v_exp_f32 v146, v146
    v_mfma_f32_16x16x32_bf16 v[48:51], a[192:195], v[176:179], v[48:51]
    v_exp_f32 v147, v147
    v_mfma_f32_16x16x32_bf16 v[80:83], a[192:195], v[180:183], v[80:83]
    ds_read_b128 a[176:179], v245 offset:33792
    v_cvt_pk_bf16_f32 v153, v146, v147
    v_mfma_f32_16x16x32_bf16 v[84:87], a[200:203], v[180:183], v[84:87]
    v_exp_f32 v148, v148
    v_mfma_f32_16x16x32_bf16 v[52:55], a[200:203], v[176:179], v[52:55]
    v_exp_f32 v149, v149
    v_mfma_f32_16x16x32_bf16 v[52:55], a[204:207], v[188:191], v[52:55]
    buffer_load_dwordx4 v247, s[20:23], s52 offen offset:1024 lds
    v_mfma_f32_16x16x32_bf16 v[20:23], a[204:207], v[184:187], v[20:23]
    ds_read_b128 a[180:183], v245 offset:33856
    v_cvt_pk_bf16_f32 v154, v148, v149
    v_mfma_f32_16x16x32_bf16 v[20:23], a[200:203], v[172:175], v[20:23]
    v_exp_f32 v150, v150
    v_mfma_f32_16x16x32_bf16 v[24:27], a[128:131], v[172:175], v[24:27]
    v_exp_f32 v151, v151
    v_mfma_f32_16x16x32_bf16 v[24:27], a[132:135], v[184:187], v[24:27]
    ds_read_b128 a[184:187], v245 offset:33920
    v_cvt_pk_bf16_f32 v155, v150, v151
    v_mfma_f32_16x16x32_bf16 v[56:59], a[132:135], v[188:191], v[56:59]
    ds_read_b128 a[188:191], v245 offset:33984
    ds_read_b128 a[192:195], v245 offset:34048
    v_mfma_f32_16x16x32_bf16 v[56:59], a[128:131], v[176:179], v[56:59]
    v_exp_f32 v96, v96
    v_mfma_f32_16x16x32_bf16 v[88:91], a[128:131], v[180:183], v[88:91]
    buffer_load_dwordx4 v248, s[20:23], s52 offen offset:2048 lds
    v_mfma_f32_16x16x32_bf16 v[92:95], a[136:139], v[180:183], v[92:95]
    v_exp_f32 v97, v97
    v_mfma_f32_16x16x32_bf16 v[60:63], a[136:139], v[176:179], v[60:63]
    ds_read_b128 a[196:199], v245 offset:34112
    v_cvt_pk_bf16_f32 v156, v96, v97
    v_mfma_f32_16x16x32_bf16 v[60:63], a[140:143], v[188:191], v[60:63]
    v_exp_f32 v98, v98
    v_mfma_f32_16x16x32_bf16 v[28:31], a[140:143], v[184:187], v[28:31]
    v_exp_f32 v99, v99
    v_mfma_f32_16x16x32_bf16 v[28:31], a[136:139], v[172:175], v[28:31]
    ds_read_b128 a[200:203], v245 offset:34176
    v_cvt_pk_bf16_f32 v157, v98, v99
    v_mfma_f32_16x16x32_bf16 v[212:215], v[224:227], v[172:175], v[212:215]
    ds_read_b128 a[204:207], v245 offset:34240
    ds_read_b64_tr_b16 a[128:129], v240 offset:0
    v_mfma_f32_16x16x32_bf16 v[212:215], v[224:227], v[184:187], v[212:215]
    buffer_load_dwordx4 v249, s[20:23], s52 offen offset:3072 lds
    v_mfma_f32_16x16x32_bf16 v[216:219], v[224:227], v[176:179], v[216:219]
    s_add_u32 m0, s73, 16896
    v_exp_f32 v104, v104
    v_mfma_f32_16x16x32_bf16 v[216:219], v[224:227], v[188:191], v[216:219]
    buffer_load_dwordx4 v250, s[12:15], s72 offen offset:0 nt lds
    v_mfma_f32_16x16x32_bf16 v[220:223], v[224:227], v[180:183], v[220:223]
    s_add_u32 s52, s52, 32768
    v_exp_f32 v105, v105
    v_mfma_f32_16x16x32_bf16 v[128:131], a[144:147], a[208:211], v[200:203]
    s_waitcnt lgkmcnt(3)
    ds_read_b64_tr_b16 a[130:131], v240 offset:256
    v_cvt_pk_bf16_f32 v160, v104, v105
    v_mfma_f32_16x16x32_bf16 v[128:131], a[148:151], a[212:215], v[128:131]
    v_exp_f32 v106, v106
    v_mfma_f32_16x16x32_bf16 v[128:131], a[152:155], a[216:219], v[128:131]
    v_exp_f32 v107, v107
    v_mfma_f32_16x16x32_bf16 v[128:131], a[156:159], a[220:223], v[128:131]
    ds_read_b64_tr_b16 a[132:133], v242 offset:0
    v_cvt_pk_bf16_f32 v161, v106, v107
    v_mfma_f32_16x16x32_bf16 v[136:139], a[156:159], a[236:239], v[204:207]
    v_exp_f32 v108, v108
    v_mfma_f32_16x16x32_bf16 v[136:139], a[152:155], a[232:235], v[136:139]
    buffer_load_dwordx4 v251, s[12:15], s72 offen offset:1056 nt lds
    v_mfma_f32_16x16x32_bf16 v[136:139], a[148:151], a[228:231], v[136:139]
    v_exp_f32 v109, v109
    v_mfma_f32_16x16x32_bf16 v[136:139], a[144:147], a[224:227], v[136:139]
    ds_read_b64_tr_b16 a[134:135], v242 offset:256
    v_cvt_pk_bf16_f32 v162, v108, v109
    v_mfma_f32_16x16x32_bf16 v[144:147], a[144:147], a[240:243], v[208:211]
    v_exp_f32 v110, v110
    v_mfma_f32_16x16x32_bf16 v[144:147], a[148:151], a[244:247], v[144:147]
    v_exp_f32 v111, v111
    v_mfma_f32_16x16x32_bf16 v[144:147], a[152:155], a[248:251], v[144:147]
    ds_read_b64_tr_b16 a[136:137], v240 offset:32
    v_cvt_pk_bf16_f32 v163, v110, v111
    v_mfma_f32_16x16x32_bf16 v[144:147], a[156:159], a[252:255], v[144:147]
    v_exp_f32 v100, v100
    v_mfma_f32_16x16x32_bf16 v[148:151], a[160:163], a[252:255], v[208:211]
    buffer_load_dwordx4 v252, s[12:15], s72 offen offset:2112 nt lds
    v_mfma_f32_16x16x32_bf16 v[148:151], a[164:167], a[248:251], v[148:151]
    v_exp_f32 v101, v101
    v_mfma_f32_16x16x32_bf16 v[148:151], a[168:171], a[244:247], v[148:151]
    ds_read_b64_tr_b16 a[138:139], v240 offset:288
    v_cvt_pk_bf16_f32 v158, v100, v101
    v_mfma_f32_16x16x32_bf16 v[148:151], a[172:175], a[240:243], v[148:151]
    v_exp_f32 v102, v102
    v_mfma_f32_16x16x32_bf16 v[140:143], a[172:175], a[224:227], v[204:207]
    v_exp_f32 v103, v103
    v_mfma_f32_16x16x32_bf16 v[140:143], a[168:171], a[228:231], v[140:143]
    ds_read_b64_tr_b16 a[140:141], v242 offset:32
    v_cvt_pk_bf16_f32 v159, v102, v103
    v_mfma_f32_16x16x32_bf16 v[140:143], a[164:167], a[232:235], v[140:143]
    ds_read_b64_tr_b16 a[142:143], v242 offset:288
    ds_read_b64_tr_b16 a[144:145], v240 offset:64
    v_mfma_f32_16x16x32_bf16 v[140:143], a[160:163], a[236:239], v[140:143]
    buffer_load_dwordx4 v253, s[12:15], s72 offen offset:3168 nt lds
    v_mfma_f32_16x16x32_bf16 v[132:135], a[160:163], a[220:223], v[200:203]
    s_add_u32 m0, s73, 84480
    v_exp_f32 v112, v112
    v_mfma_f32_16x16x32_bf16 v[132:135], a[164:167], a[216:219], v[132:135]
    v_exp_f32 v113, v113
    v_mfma_f32_16x16x32_bf16 v[132:135], a[168:171], a[212:215], v[132:135]
    ds_read_b64_tr_b16 a[146:147], v240 offset:320
    v_cvt_pk_bf16_f32 v164, v112, v113
    v_mfma_f32_16x16x32_bf16 v[132:135], a[172:175], a[208:211], v[132:135]
    v_exp_f32 v114, v114
    v_mfma_f32_16x16x32_bf16 v[96:99], a[176:179], a[208:211], v[200:203]
    v_exp_f32 v115, v115
    v_mfma_f32_16x16x32_bf16 v[96:99], a[180:183], a[212:215], v[96:99]
    ds_read_b64_tr_b16 a[148:149], v242 offset:64
    v_cvt_pk_bf16_f32 v165, v114, v115
    v_mfma_f32_16x16x32_bf16 v[96:99], a[184:187], a[216:219], v[96:99]
    v_exp_f32 v116, v116
    v_mfma_f32_16x16x32_bf16 v[96:99], a[188:191], a[220:223], v[96:99]
    v_exp_f32 v117, v117
    v_mfma_f32_16x16x32_bf16 v[104:107], a[188:191], a[236:239], v[204:207]
    ds_read_b64_tr_b16 a[150:151], v242 offset:320
    v_cvt_pk_bf16_f32 v166, v116, v117
    v_mfma_f32_16x16x32_bf16 v[104:107], a[184:187], a[232:235], v[104:107]
    v_exp_f32 v118, v118
    v_mfma_f32_16x16x32_bf16 v[104:107], a[180:183], a[228:231], v[104:107]
    v_exp_f32 v119, v119
    v_mfma_f32_16x16x32_bf16 v[104:107], a[176:179], a[224:227], v[104:107]
    ds_read_b64_tr_b16 a[152:153], v240 offset:96
    v_cvt_pk_bf16_f32 v167, v118, v119
    v_mfma_f32_16x16x32_bf16 v[108:111], a[192:195], a[224:227], v[204:207]
    v_exp_f32 v120, v120
    v_mfma_f32_16x16x32_bf16 v[108:111], a[196:199], a[228:231], v[108:111]
    s_waitcnt lgkmcnt(2)
    v_exp_f32 v121, v121
    v_mfma_f32_16x16x32_bf16 v[108:111], a[200:203], a[232:235], v[108:111]
    ds_read_b64_tr_b16 a[154:155], v240 offset:352
    v_cvt_pk_bf16_f32 v168, v120, v121
    v_mfma_f32_16x16x32_bf16 v[108:111], a[204:207], a[236:239], v[108:111]
    v_exp_f32 v122, v122
    v_mfma_f32_16x16x32_bf16 v[100:103], a[204:207], a[220:223], v[200:203]
    v_exp_f32 v123, v123
    v_mfma_f32_16x16x32_bf16 v[100:103], a[200:203], a[216:219], v[100:103]
    ds_read_b64_tr_b16 a[156:157], v242 offset:96
    v_cvt_pk_bf16_f32 v169, v122, v123
    v_mfma_f32_16x16x32_bf16 v[100:103], a[196:199], a[212:215], v[100:103]
    v_exp_f32 v124, v124
    v_mfma_f32_16x16x32_bf16 v[100:103], a[192:195], a[208:211], v[100:103]
    v_exp_f32 v125, v125
    v_mfma_f32_16x16x32_bf16 v[0:3], a[128:131], v[152:155], v[0:3]
    ds_read_b64_tr_b16 a[158:159], v242 offset:352
    v_cvt_pk_bf16_f32 v170, v124, v125
    v_mfma_f32_16x16x32_bf16 v[0:3], a[132:135], v[164:167], v[0:3]
    v_exp_f32 v126, v126
    v_exp_f32 v127, v127
    ds_read_b64_tr_b16 a[160:161], v241 offset:0
    v_cvt_pk_bf16_f32 v171, v126, v127
    s_nop 1
    v_mfma_f32_16x16x32_bf16 v[32:35], a[132:135], v[168:171], v[32:35]
    ds_read_b64_tr_b16 a[162:163], v241 offset:256
    ds_read_b64_tr_b16 a[164:165], v243 offset:0
    v_mfma_f32_16x16x32_bf16 v[32:35], a[128:131], v[156:159], v[32:35]
    ds_read_b64_tr_b16 a[166:167], v243 offset:256
    ds_read_b64_tr_b16 a[168:169], v241 offset:32
    v_mfma_f32_16x16x32_bf16 v[64:67], a[128:131], v[160:163], v[64:67]
    ds_read_b64_tr_b16 a[170:171], v241 offset:288
    ds_read_b64_tr_b16 a[172:173], v243 offset:32
    v_mfma_f32_16x16x32_bf16 v[68:71], a[136:139], v[160:163], v[68:71]
    ds_read_b64_tr_b16 a[174:175], v243 offset:288
    ds_read_b64_tr_b16 a[176:177], v241 offset:64
    v_mfma_f32_16x16x32_bf16 v[36:39], a[136:139], v[156:159], v[36:39]
    s_waitcnt vmcnt(8)
    ds_read_b64_tr_b16 a[178:179], v241 offset:320
    ds_read_b64_tr_b16 a[180:181], v243 offset:64
    v_mfma_f32_16x16x32_bf16 v[36:39], a[140:143], v[168:171], v[36:39]
    s_barrier
    ds_read_b64_tr_b16 a[182:183], v243 offset:320
    ds_read_b64_tr_b16 a[184:185], v241 offset:96
    v_mfma_f32_16x16x32_bf16 v[4:7], a[140:143], v[164:167], v[4:7]
    s_lshl_b32 s65, s42, 2
    ds_read_b64_tr_b16 a[186:187], v241 offset:352
    ds_read_b64_tr_b16 a[188:189], v243 offset:96
    v_mfma_f32_16x16x32_bf16 v[4:7], a[136:139], v[152:155], v[4:7]
    buffer_load_dwordx4 v250, s[16:19], s74 offen offset:0 nt lds
    v_mfma_f32_16x16x32_bf16 v[8:11], a[144:147], v[152:155], v[8:11]
    s_waitcnt lgkmcnt(8)
    ds_read_b64_tr_b16 a[190:191], v243 offset:352
    ds_read_b128 a[192:195], v244 offset:0
    v_mfma_f32_16x16x32_bf16 v[8:11], a[148:151], v[164:167], v[8:11]
    ds_read_b128 a[196:199], v244 offset:64
    ds_read_b128 a[200:203], v244 offset:128
    v_mfma_f32_16x16x32_bf16 v[40:43], a[148:151], v[168:171], v[40:43]
    buffer_load_dwordx4 v251, s[16:19], s74 offen offset:1056 nt lds
    v_mfma_f32_16x16x32_bf16 v[40:43], a[144:147], v[156:159], v[40:43]
    ds_read_b128 a[204:207], v244 offset:192
    ds_read_b128 a[128:131], v244 offset:448
    v_mfma_f32_16x16x32_bf16 v[72:75], a[144:147], v[160:163], v[72:75]
    v_exp_f32 v128, v128
    v_mfma_f32_16x16x32_bf16 v[76:79], a[152:155], v[160:163], v[76:79]
    buffer_load_dwordx4 v252, s[16:19], s74 offen offset:2112 nt lds
    v_mfma_f32_16x16x32_bf16 v[44:47], a[152:155], v[156:159], v[44:47]
    ds_read_b128 a[132:135], v244 offset:384
    ds_read_b128 a[136:139], v244 offset:320
    v_mfma_f32_16x16x32_bf16 v[44:47], a[156:159], v[168:171], v[44:47]
    v_exp_f32 v129, v129
    v_mfma_f32_16x16x32_bf16 v[12:15], a[156:159], v[164:167], v[12:15]
    buffer_load_dwordx4 v253, s[16:19], s74 offen offset:3168 nt lds
    v_mfma_f32_16x16x32_bf16 v[12:15], a[152:155], v[152:155], v[12:15]
    s_add_u32 m0, s77, 118272
    ds_read_b128 a[140:143], v244 offset:256
    v_cvt_pk_bf16_f32 v172, v128, v129
    v_mfma_f32_16x16x32_bf16 v[16:19], a[160:163], v[152:155], v[16:19]
    buffer_load_dwordx4 v246, s[20:23], s52 offen offset:0 lds
    v_mfma_f32_16x16x32_bf16 v[16:19], a[164:167], v[164:167], v[16:19]
    s_add_u32 s74, s40, 114688
    v_exp_f32 v130, v130
    v_mfma_f32_16x16x32_bf16 v[48:51], a[164:167], v[168:171], v[48:51]
    v_exp_f32 v131, v131
    v_mfma_f32_16x16x32_bf16 v[48:51], a[160:163], v[156:159], v[48:51]
    ds_read_b128 a[144:147], v245 offset:0
    v_cvt_pk_bf16_f32 v173, v130, v131
    v_mfma_f32_16x16x32_bf16 v[80:83], a[160:163], v[160:163], v[80:83]
    v_exp_f32 v132, v132
    v_mfma_f32_16x16x32_bf16 v[84:87], a[168:171], v[160:163], v[84:87]
    v_exp_f32 v133, v133
    v_mfma_f32_16x16x32_bf16 v[52:55], a[168:171], v[156:159], v[52:55]
    s_waitcnt lgkmcnt(1)
    ds_read_b128 a[148:151], v245 offset:64
    v_cvt_pk_bf16_f32 v174, v132, v133
    v_mfma_f32_16x16x32_bf16 v[52:55], a[172:175], v[168:171], v[52:55]
    buffer_load_dwordx4 v247, s[20:23], s52 offen offset:1024 lds
    v_mfma_f32_16x16x32_bf16 v[20:23], a[172:175], v[164:167], v[20:23]
    v_exp_f32 v134, v134
    v_mfma_f32_16x16x32_bf16 v[20:23], a[168:171], v[152:155], v[20:23]
    v_exp_f32 v135, v135
    v_mfma_f32_16x16x32_bf16 v[24:27], a[176:179], v[152:155], v[24:27]
    ds_read_b128 a[152:155], v245 offset:128
    v_cvt_pk_bf16_f32 v175, v134, v135
    v_mfma_f32_16x16x32_bf16 v[24:27], a[180:183], v[164:167], v[24:27]
    ds_read_b128 a[156:159], v245 offset:192
    ds_read_b128 a[160:163], v245 offset:256
    v_mfma_f32_16x16x32_bf16 v[56:59], a[180:183], v[168:171], v[56:59]
    v_exp_f32 v136, v136
    v_mfma_f32_16x16x32_bf16 v[56:59], a[176:179], v[156:159], v[56:59]
    v_exp_f32 v137, v137
    v_mfma_f32_16x16x32_bf16 v[88:91], a[176:179], v[160:163], v[88:91]
    buffer_load_dwordx4 v248, s[20:23], s52 offen offset:2048 lds
    v_mfma_f32_16x16x32_bf16 v[92:95], a[184:187], v[160:163], v[92:95]
    ds_read_b128 a[164:167], v245 offset:320
    v_cvt_pk_bf16_f32 v176, v136, v137
    v_mfma_f32_16x16x32_bf16 v[60:63], a[184:187], v[156:159], v[60:63]
    v_exp_f32 v138, v138
    v_mfma_f32_16x16x32_bf16 v[60:63], a[188:191], v[168:171], v[60:63]
    v_exp_f32 v139, v139
    v_mfma_f32_16x16x32_bf16 v[28:31], a[188:191], v[164:167], v[28:31]
    ds_read_b128 a[168:171], v245 offset:384
    v_cvt_pk_bf16_f32 v177, v138, v139
    v_mfma_f32_16x16x32_bf16 v[28:31], a[184:187], v[152:155], v[28:31]
    ds_read_b128 a[172:175], v245 offset:448
    ds_read_b64_tr_b16 a[176:177], v240 offset:16896
    v_mfma_f32_16x16x32_bf16 v[212:215], v[224:227], v[152:155], v[212:215]
    v_exp_f32 v144, v144
    v_mfma_f32_16x16x32_bf16 v[212:215], v[224:227], v[164:167], v[212:215]
    buffer_load_dwordx4 v249, s[20:23], s52 offen offset:3072 lds
    v_mfma_f32_16x16x32_bf16 v[216:219], v[224:227], v[156:159], v[216:219]
    s_add_u32 s52, s52, 32768
    v_exp_f32 v145, v145
    v_mfma_f32_16x16x32_bf16 v[216:219], v[224:227], v[168:171], v[216:219]
    s_add_u32 m0, s77, 134656
    ds_read_b64_tr_b16 a[178:179], v240 offset:17152
    v_cvt_pk_bf16_f32 v180, v144, v145
    v_mfma_f32_16x16x32_bf16 v[220:223], v[224:227], v[160:163], v[220:223]
    v_exp_f32 v146, v146
    v_mfma_f32_16x16x32_bf16 v[112:115], a[192:195], a[208:211], v[200:203]
    v_exp_f32 v147, v147
    v_mfma_f32_16x16x32_bf16 v[112:115], a[196:199], a[212:215], v[112:115]
    ds_read_b64_tr_b16 a[180:181], v242 offset:16896
    v_cvt_pk_bf16_f32 v181, v146, v147
    v_mfma_f32_16x16x32_bf16 v[112:115], a[200:203], a[216:219], v[112:115]
    v_exp_f32 v148, v148
    v_mfma_f32_16x16x32_bf16 v[112:115], a[204:207], a[220:223], v[112:115]
    v_exp_f32 v149, v149
    v_mfma_f32_16x16x32_bf16 v[120:123], a[204:207], a[236:239], v[204:207]
    ds_read_b64_tr_b16 a[182:183], v242 offset:17152
    v_cvt_pk_bf16_f32 v182, v148, v149
    v_mfma_f32_16x16x32_bf16 v[120:123], a[200:203], a[232:235], v[120:123]
    v_exp_f32 v150, v150
    v_mfma_f32_16x16x32_bf16 v[120:123], a[196:199], a[228:231], v[120:123]
    v_exp_f32 v151, v151
    v_mfma_f32_16x16x32_bf16 v[120:123], a[192:195], a[224:227], v[120:123]
    ds_read_b64_tr_b16 a[184:185], v240 offset:16928
    v_cvt_pk_bf16_f32 v183, v150, v151
    v_mfma_f32_16x16x32_bf16 v[128:131], a[192:195], a[240:243], v[208:211]
    v_exp_f32 v140, v140
    v_mfma_f32_16x16x32_bf16 v[128:131], a[196:199], a[244:247], v[128:131]
    v_exp_f32 v141, v141
    v_mfma_f32_16x16x32_bf16 v[128:131], a[200:203], a[248:251], v[128:131]
    ds_read_b64_tr_b16 a[186:187], v240 offset:17184
    v_cvt_pk_bf16_f32 v178, v140, v141
    v_mfma_f32_16x16x32_bf16 v[128:131], a[204:207], a[252:255], v[128:131]
    v_exp_f32 v142, v142
    v_mfma_f32_16x16x32_bf16 v[132:135], a[128:131], a[252:255], v[208:211]
    v_exp_f32 v143, v143
    v_mfma_f32_16x16x32_bf16 v[132:135], a[132:135], a[248:251], v[132:135]
    ds_read_b64_tr_b16 a[188:189], v242 offset:16928
    v_cvt_pk_bf16_f32 v179, v142, v143
    v_mfma_f32_16x16x32_bf16 v[132:135], a[136:139], a[244:247], v[132:135]
    ds_read_b64_tr_b16 a[190:191], v242 offset:17184
    ds_read_b64_tr_b16 a[192:193], v240 offset:16960
    v_mfma_f32_16x16x32_bf16 v[132:135], a[140:143], a[240:243], v[132:135]
    v_exp_f32 v96, v96
    v_mfma_f32_16x16x32_bf16 v[124:127], a[140:143], a[224:227], v[204:207]
    s_waitcnt vmcnt(12)
    ds_read_b64_tr_b16 a[16:17], v231 offset:16384
    ds_read_b64_tr_b16 a[18:19], v231 offset:18432
    v_mfma_f32_16x16x32_bf16 v[124:127], a[136:139], a[228:231], v[124:127]
    ds_read_b64_tr_b16 a[20:21], v232 offset:16384
    ds_read_b64_tr_b16 a[22:23], v232 offset:18432
    v_mfma_f32_16x16x32_bf16 v[124:127], a[132:135], a[232:235], v[124:127]
    ds_read_b64_tr_b16 a[24:25], v233 offset:16384
    ds_read_b64_tr_b16 a[26:27], v233 offset:18432
    v_mfma_f32_16x16x32_bf16 v[124:127], a[128:131], a[236:239], v[124:127]
    ds_read_b64_tr_b16 a[28:29], v234 offset:16384
    ds_read_b64_tr_b16 a[30:31], v234 offset:18432
    v_mfma_f32_16x16x32_bf16 v[116:119], a[128:131], a[220:223], v[200:203]
    v_exp_f32 v97, v97
    v_mfma_f32_16x16x32_bf16 v[116:119], a[132:135], a[216:219], v[116:119]
    ds_read_b64_tr_b16 a[194:195], v240 offset:17216
    v_cvt_pk_bf16_f32 v184, v96, v97
    v_mfma_f32_16x16x32_bf16 v[116:119], a[136:139], a[212:215], v[116:119]
    v_exp_f32 v98, v98
    v_mfma_f32_16x16x32_bf16 v[116:119], a[140:143], a[208:211], v[116:119]
    s_waitcnt lgkmcnt(6)
    v_exp_f32 v99, v99
    v_mfma_f32_16x16x32_bf16 v[136:139], a[144:147], a[208:211], v[200:203]
    ds_read_b64_tr_b16 a[196:197], v242 offset:16960
    v_cvt_pk_bf16_f32 v185, v98, v99
    v_mfma_f32_16x16x32_bf16 v[136:139], a[148:151], a[212:215], v[136:139]
    v_exp_f32 v100, v100
    v_mfma_f32_16x16x32_bf16 v[136:139], a[152:155], a[216:219], v[136:139]
    s_waitcnt lgkmcnt(2)
    v_exp_f32 v101, v101
    v_mfma_f32_16x16x32_bf16 v[136:139], a[156:159], a[220:223], v[136:139]
    buffer_load_dwordx4 v246, s[20:23], s52 offen offset:0 lds
    v_mfma_f32_16x16x32_bf16 v[144:147], a[156:159], a[236:239], v[204:207]
    ds_read_b64_tr_b16 a[198:199], v242 offset:17216
    v_cvt_pk_bf16_f32 v186, v100, v101
    v_mfma_f32_16x16x32_bf16 v[144:147], a[152:155], a[232:235], v[144:147]
    v_exp_f32 v102, v102
    v_mfma_f32_16x16x32_bf16 v[144:147], a[148:151], a[228:231], v[144:147]
    v_exp_f32 v103, v103
    v_mfma_f32_16x16x32_bf16 v[144:147], a[144:147], a[224:227], v[144:147]
    ds_read_b64_tr_b16 a[200:201], v240 offset:16992
    v_cvt_pk_bf16_f32 v187, v102, v103
    v_mfma_f32_16x16x32_bf16 v[148:151], a[160:163], a[224:227], v[204:207]
    v_exp_f32 v104, v104
    v_mfma_f32_16x16x32_bf16 v[148:151], a[164:167], a[228:231], v[148:151]
    v_exp_f32 v105, v105
    v_mfma_f32_16x16x32_bf16 v[148:151], a[168:171], a[232:235], v[148:151]
    buffer_load_dwordx4 v247, s[20:23], s52 offen offset:1024 lds
    v_mfma_f32_16x16x32_bf16 v[148:151], a[172:175], a[236:239], v[148:151]
    ds_read_b64_tr_b16 a[202:203], v240 offset:17248
    v_cvt_pk_bf16_f32 v188, v104, v105
    v_mfma_f32_16x16x32_bf16 v[140:143], a[172:175], a[220:223], v[200:203]
    v_exp_f32 v106, v106
    v_mfma_f32_16x16x32_bf16 v[140:143], a[168:171], a[216:219], v[140:143]
    v_exp_f32 v107, v107
    v_mfma_f32_16x16x32_bf16 v[140:143], a[164:167], a[212:215], v[140:143]
    ds_read_b64_tr_b16 a[204:205], v242 offset:16992
    v_cvt_pk_bf16_f32 v189, v106, v107
    v_mfma_f32_16x16x32_bf16 v[140:143], a[160:163], a[208:211], v[140:143]
    v_exp_f32 v108, v108
    v_mfma_f32_16x16x32_bf16 v[0:3], a[176:179], v[172:175], v[0:3]
    v_exp_f32 v109, v109
    v_mfma_f32_16x16x32_bf16 v[0:3], a[180:183], v[184:187], v[0:3]
    ds_read_b64_tr_b16 a[206:207], v242 offset:17248
    v_cvt_pk_bf16_f32 v190, v108, v109
    v_exp_f32 v110, v110
    v_exp_f32 v111, v111
    buffer_load_dwordx4 v248, s[20:23], s52 offen offset:2048 lds
    v_cvt_pk_bf16_f32 v191, v110, v111
    s_nop 1
    v_mfma_f32_16x16x32_bf16 v[32:35], a[180:183], v[188:191], v[32:35]
    ds_read_b64_tr_b16 a[128:129], v241 offset:16896
    ds_read_b64_tr_b16 a[130:131], v241 offset:17152
    v_mfma_f32_16x16x32_bf16 v[32:35], a[176:179], v[176:179], v[32:35]
    ds_read_b64_tr_b16 a[132:133], v243 offset:16896
    ds_read_b64_tr_b16 a[134:135], v243 offset:17152
    v_mfma_f32_16x16x32_bf16 v[64:67], a[176:179], v[180:183], v[64:67]
    ds_read_b64_tr_b16 a[136:137], v241 offset:16928
    ds_read_b64_tr_b16 a[138:139], v241 offset:17184
    v_mfma_f32_16x16x32_bf16 v[68:71], a[184:187], v[180:183], v[68:71]
    ds_read_b64_tr_b16 a[140:141], v243 offset:16928
    ds_read_b64_tr_b16 a[142:143], v243 offset:17184
    v_mfma_f32_16x16x32_bf16 v[36:39], a[184:187], v[176:179], v[36:39]
    s_waitcnt vmcnt(7)
    ds_read_b64_tr_b16 a[144:145], v241 offset:16960
    ds_read_b64_tr_b16 a[146:147], v241 offset:17216
    v_mfma_f32_16x16x32_bf16 v[36:39], a[188:191], v[188:191], v[36:39]
    buffer_load_dwordx4 v249, s[20:23], s52 offen offset:3072 lds
    v_mfma_f32_16x16x32_bf16 v[4:7], a[188:191], v[184:187], v[4:7]
    buffer_load_dword v228, off, s[48:51], s65 sc1
    v_mfma_f32_16x16x32_bf16 v[4:7], a[184:187], v[172:175], v[4:7]
    s_waitcnt lgkmcnt(7)
    ds_read_b64_tr_b16 a[148:149], v243 offset:16960
    ds_read_b64_tr_b16 a[150:151], v243 offset:17216
    v_mfma_f32_16x16x32_bf16 v[8:11], a[192:195], v[172:175], v[8:11]
    s_add_u32 m0, s73, 101376
    ds_read_b64_tr_b16 a[152:153], v241 offset:16992
    ds_read_b64_tr_b16 a[154:155], v241 offset:17248
    v_mfma_f32_16x16x32_bf16 v[8:11], a[196:199], v[184:187], v[8:11]
    s_add_u32 s52, s80, 1
    ds_read_b64_tr_b16 a[156:157], v243 offset:16992
    ds_read_b64_tr_b16 a[158:159], v243 offset:17248
    v_mfma_f32_16x16x32_bf16 v[40:43], a[196:199], v[188:191], v[40:43]
    s_and_b32 s52, s52, 3
    v_exp_f32 v112, v112
    v_mfma_f32_16x16x32_bf16 v[40:43], a[192:195], v[176:179], v[40:43]
    s_lshl_b32 s52, s52, 18
    v_exp_f32 v113, v113
    v_mfma_f32_16x16x32_bf16 v[72:75], a[192:195], v[180:183], v[72:75]
    s_add_u32 s52, s52, s76
    v_exp_f32 v114, v114
    v_mfma_f32_16x16x32_bf16 v[76:79], a[200:203], v[180:183], v[76:79]
    s_barrier
    ds_read_b128 a[160:163], v244 offset:16896
    ds_read_b128 a[164:167], v244 offset:16960
    v_mfma_f32_16x16x32_bf16 v[44:47], a[200:203], v[176:179], v[44:47]
    buffer_load_dwordx4 v250, s[16:19], s74 offen offset:0 nt lds
    v_mfma_f32_16x16x32_bf16 v[44:47], a[204:207], v[188:191], v[44:47]
    s_and_b32 s65, s60, 2
    ds_read_b128 a[168:171], v244 offset:17024
    ds_read_b128 a[172:175], v244 offset:17088
    v_mfma_f32_16x16x32_bf16 v[12:15], a[204:207], v[184:187], v[12:15]
    s_mul_i32 s65, s65, 10240
    ds_read_b128 a[176:179], v244 offset:17344
    v_cvt_pk_bf16_f32 v152, v112, v113
    v_mfma_f32_16x16x32_bf16 v[12:15], a[200:203], v[172:175], v[12:15]
    buffer_load_dwordx4 v251, s[16:19], s74 offen offset:1056 nt lds
    v_mfma_f32_16x16x32_bf16 v[16:19], a[128:131], v[172:175], v[16:19]
    s_waitcnt lgkmcnt(5)
    ds_read_b128 a[180:183], v244 offset:17280
    ds_read_b128 a[184:187], v244 offset:17216
    v_mfma_f32_16x16x32_bf16 v[16:19], a[132:135], v[184:187], v[16:19]
    v_exp_f32 v115, v115
    v_mfma_f32_16x16x32_bf16 v[48:51], a[132:135], v[188:191], v[48:51]
    buffer_load_dwordx4 v252, s[16:19], s74 offen offset:2112 nt lds
    v_mfma_f32_16x16x32_bf16 v[48:51], a[128:131], v[176:179], v[48:51]
    ds_read_b128 a[188:191], v244 offset:17152
    v_cvt_pk_bf16_f32 v153, v114, v115
    v_mfma_f32_16x16x32_bf16 v[80:83], a[128:131], v[180:183], v[80:83]
    v_exp_f32 v116, v116
    v_mfma_f32_16x16x32_bf16 v[84:87], a[136:139], v[180:183], v[84:87]
    buffer_load_dwordx4 v253, s[16:19], s74 offen offset:3168 nt lds
    v_mfma_f32_16x16x32_bf16 v[52:55], a[136:139], v[176:179], v[52:55]
    s_add_u32 m0, s77, 118272
    v_exp_f32 v117, v117
    v_mfma_f32_16x16x32_bf16 v[52:55], a[140:143], v[188:191], v[52:55]
    ds_read_b128 a[192:195], v245 offset:16896
    v_cvt_pk_bf16_f32 v154, v116, v117
    v_mfma_f32_16x16x32_bf16 v[20:23], a[140:143], v[184:187], v[20:23]
    v_exp_f32 v118, v118
    v_mfma_f32_16x16x32_bf16 v[20:23], a[136:139], v[172:175], v[20:23]
    v_exp_f32 v119, v119
    v_mfma_f32_16x16x32_bf16 v[24:27], a[144:147], v[172:175], v[24:27]
    ds_read_b128 a[196:199], v245 offset:16960
    v_cvt_pk_bf16_f32 v155, v118, v119
    v_mfma_f32_16x16x32_bf16 v[24:27], a[148:151], v[184:187], v[24:27]
    ds_read_b128 a[200:203], v245 offset:17024
    ds_read_b128 a[204:207], v245 offset:17088
    v_mfma_f32_16x16x32_bf16 v[56:59], a[148:151], v[188:191], v[56:59]
    v_exp_f32 v120, v120
    v_mfma_f32_16x16x32_bf16 v[56:59], a[144:147], v[176:179], v[56:59]
    v_exp_f32 v121, v121
    v_mfma_f32_16x16x32_bf16 v[88:91], a[144:147], v[180:183], v[88:91]
    ds_read_b128 a[128:131], v245 offset:17152
    v_cvt_pk_bf16_f32 v156, v120, v121
    v_mfma_f32_16x16x32_bf16 v[92:95], a[152:155], v[180:183], v[92:95]
    v_exp_f32 v122, v122
    v_mfma_f32_16x16x32_bf16 v[60:63], a[152:155], v[176:179], v[60:63]
    v_exp_f32 v123, v123
    v_mfma_f32_16x16x32_bf16 v[60:63], a[156:159], v[188:191], v[60:63]
    ds_read_b128 a[132:135], v245 offset:17216
    v_cvt_pk_bf16_f32 v157, v122, v123
    v_mfma_f32_16x16x32_bf16 v[28:31], a[156:159], v[184:187], v[28:31]
    ds_read_b128 a[136:139], v245 offset:17280
    ds_read_b128 a[140:143], v245 offset:17344
    v_mfma_f32_16x16x32_bf16 v[28:31], a[152:155], v[172:175], v[28:31]
    v_exp_f32 v128, v128
    v_mfma_f32_16x16x32_bf16 v[212:215], v[224:227], v[172:175], v[212:215]
    v_exp_f32 v129, v129
    v_mfma_f32_16x16x32_bf16 v[212:215], v[224:227], v[184:187], v[212:215]
    ds_read_b64_tr_b16 a[144:145], v241 offset:33792
    v_cvt_pk_bf16_f32 v160, v128, v129
    v_mfma_f32_16x16x32_bf16 v[216:219], v[224:227], v[176:179], v[216:219]
    v_exp_f32 v130, v130
    v_mfma_f32_16x16x32_bf16 v[216:219], v[224:227], v[188:191], v[216:219]
    v_exp_f32 v131, v131
    v_mfma_f32_16x16x32_bf16 v[220:223], v[224:227], v[180:183], v[220:223]
    s_waitcnt lgkmcnt(3)
    ds_read_b64_tr_b16 a[146:147], v241 offset:34048
    v_cvt_pk_bf16_f32 v161, v130, v131
    v_mfma_f32_16x16x32_bf16 v[96:99], a[160:163], a[208:211], v[200:203]
    v_exp_f32 v132, v132
    v_mfma_f32_16x16x32_bf16 v[96:99], a[164:167], a[212:215], v[96:99]
    v_exp_f32 v133, v133
    v_mfma_f32_16x16x32_bf16 v[96:99], a[168:171], a[216:219], v[96:99]
    ds_read_b64_tr_b16 a[148:149], v243 offset:33792
    v_cvt_pk_bf16_f32 v162, v132, v133
    v_mfma_f32_16x16x32_bf16 v[96:99], a[172:175], a[220:223], v[96:99]
    v_exp_f32 v134, v134
    v_mfma_f32_16x16x32_bf16 v[104:107], a[172:175], a[236:239], v[204:207]
    v_exp_f32 v135, v135
    v_mfma_f32_16x16x32_bf16 v[104:107], a[168:171], a[232:235], v[104:107]
    ds_read_b64_tr_b16 a[150:151], v243 offset:34048
    v_cvt_pk_bf16_f32 v163, v134, v135
    v_mfma_f32_16x16x32_bf16 v[104:107], a[164:167], a[228:231], v[104:107]
    v_exp_f32 v124, v124
    v_mfma_f32_16x16x32_bf16 v[104:107], a[160:163], a[224:227], v[104:107]
    v_exp_f32 v125, v125
    v_mfma_f32_16x16x32_bf16 v[112:115], a[160:163], a[240:243], v[208:211]
    ds_read_b64_tr_b16 a[152:153], v241 offset:33824
    v_cvt_pk_bf16_f32 v158, v124, v125
    v_mfma_f32_16x16x32_bf16 v[112:115], a[164:167], a[244:247], v[112:115]
    v_exp_f32 v126, v126
    v_mfma_f32_16x16x32_bf16 v[112:115], a[168:171], a[248:251], v[112:115]
    v_exp_f32 v127, v127
    v_mfma_f32_16x16x32_bf16 v[112:115], a[172:175], a[252:255], v[112:115]
    ds_read_b64_tr_b16 a[154:155], v241 offset:34080
    v_cvt_pk_bf16_f32 v159, v126, v127
    v_mfma_f32_16x16x32_bf16 v[116:119], a[176:179], a[252:255], v[208:211]
    ds_read_b64_tr_b16 a[156:157], v243 offset:33824
    ds_read_b64_tr_b16 a[158:159], v243 offset:34080
    v_mfma_f32_16x16x32_bf16 v[116:119], a[180:183], a[248:251], v[116:119]
    v_exp_f32 v136, v136
    v_mfma_f32_16x16x32_bf16 v[116:119], a[184:187], a[244:247], v[116:119]
    v_exp_f32 v137, v137
    v_mfma_f32_16x16x32_bf16 v[116:119], a[188:191], a[240:243], v[116:119]
    ds_read_b64_tr_b16 a[160:161], v241 offset:33856
    v_cvt_pk_bf16_f32 v164, v136, v137
    v_mfma_f32_16x16x32_bf16 v[108:111], a[188:191], a[224:227], v[204:207]
    v_exp_f32 v138, v138
    v_mfma_f32_16x16x32_bf16 v[108:111], a[184:187], a[228:231], v[108:111]
    v_exp_f32 v139, v139
    v_mfma_f32_16x16x32_bf16 v[108:111], a[180:183], a[232:235], v[108:111]
    ds_read_b64_tr_b16 a[162:163], v241 offset:34112
    v_cvt_pk_bf16_f32 v165, v138, v139
    v_mfma_f32_16x16x32_bf16 v[108:111], a[176:179], a[236:239], v[108:111]
    v_exp_f32 v140, v140
    v_mfma_f32_16x16x32_bf16 v[100:103], a[176:179], a[220:223], v[200:203]
    v_exp_f32 v141, v141
    v_mfma_f32_16x16x32_bf16 v[100:103], a[180:183], a[216:219], v[100:103]
    ds_read_b64_tr_b16 a[164:165], v243 offset:33856
    v_cvt_pk_bf16_f32 v166, v140, v141
    v_mfma_f32_16x16x32_bf16 v[100:103], a[184:187], a[212:215], v[100:103]
    v_exp_f32 v142, v142
    v_mfma_f32_16x16x32_bf16 v[100:103], a[188:191], a[208:211], v[100:103]
    v_exp_f32 v143, v143
    v_mfma_f32_16x16x32_bf16 v[120:123], a[192:195], a[208:211], v[200:203]
    s_waitcnt vmcnt(9)
    ds_read_b64_tr_b16 a[32:33], v231 offset:0
    ds_read_b64_tr_b16 a[34:35], v231 offset:2048
    v_mfma_f32_16x16x32_bf16 v[120:123], a[196:199], a[212:215], v[120:123]
    s_waitcnt vmcnt(5)
    ds_read_b64_tr_b16 a[36:37], v232 offset:0
    ds_read_b64_tr_b16 a[38:39], v232 offset:2048
    v_mfma_f32_16x16x32_bf16 v[120:123], a[200:203], a[216:219], v[120:123]
    ds_read_b64_tr_b16 a[40:41], v233 offset:0
    ds_read_b64_tr_b16 a[42:43], v233 offset:2048
    v_mfma_f32_16x16x32_bf16 v[120:123], a[204:207], a[220:223], v[120:123]
    ds_read_b64_tr_b16 a[44:45], v234 offset:0
    ds_read_b64_tr_b16 a[46:47], v234 offset:2048
    v_mfma_f32_16x16x32_bf16 v[128:131], a[204:207], a[236:239], v[204:207]
    ds_read_b64_tr_b16 a[48:49], v231 offset:16384
    ds_read_b64_tr_b16 a[50:51], v231 offset:18432
    v_mfma_f32_16x16x32_bf16 v[128:131], a[200:203], a[232:235], v[128:131]
    ds_read_b64_tr_b16 a[52:53], v232 offset:16384
    ds_read_b64_tr_b16 a[54:55], v232 offset:18432
    v_mfma_f32_16x16x32_bf16 v[128:131], a[196:199], a[228:231], v[128:131]
    ds_read_b64_tr_b16 a[56:57], v233 offset:16384
    ds_read_b64_tr_b16 a[58:59], v233 offset:18432
    v_mfma_f32_16x16x32_bf16 v[128:131], a[192:195], a[224:227], v[128:131]
    ds_read_b64_tr_b16 a[60:61], v234 offset:16384
    ds_read_b64_tr_b16 a[62:63], v234 offset:18432
    v_mfma_f32_16x16x32_bf16 v[132:135], a[128:131], a[224:227], v[204:207]
    ds_read_b64_tr_b16 a[166:167], v243 offset:34112
    v_cvt_pk_bf16_f32 v167, v142, v143
    v_mfma_f32_16x16x32_bf16 v[132:135], a[132:135], a[228:231], v[132:135]
    s_waitcnt lgkmcnt(10)
    v_exp_f32 v144, v144
    v_mfma_f32_16x16x32_bf16 v[132:135], a[136:139], a[232:235], v[132:135]
    s_waitcnt lgkmcnt(9)
    v_exp_f32 v145, v145
    v_mfma_f32_16x16x32_bf16 v[132:135], a[140:143], a[236:239], v[132:135]
    buffer_load_dwordx4 v246, s[20:23], s52 offen offset:0 lds
    v_mfma_f32_16x16x32_bf16 v[124:127], a[140:143], a[220:223], v[200:203]
    ds_read_b64_tr_b16 a[168:169], v241 offset:33888
    v_cvt_pk_bf16_f32 v168, v144, v145
    v_mfma_f32_16x16x32_bf16 v[124:127], a[136:139], a[216:219], v[124:127]
    v_exp_f32 v146, v146
    v_mfma_f32_16x16x32_bf16 v[124:127], a[132:135], a[212:215], v[124:127]
    buffer_load_dwordx4 v247, s[20:23], s52 offen offset:1024 lds
    v_mfma_f32_16x16x32_bf16 v[124:127], a[128:131], a[208:211], v[124:127]
    s_waitcnt lgkmcnt(2)
    v_exp_f32 v147, v147
    v_mfma_f32_16x16x32_bf16 v[16:19], a[144:147], v[152:155], v[16:19]
    ds_read_b64_tr_b16 a[170:171], v241 offset:34144
    v_cvt_pk_bf16_f32 v169, v146, v147
    v_mfma_f32_16x16x32_bf16 v[16:19], a[148:151], v[164:167], v[16:19]
    v_exp_f32 v148, v148
    v_exp_f32 v149, v149
    v_exp_f32 v150, v150
    v_cvt_pk_bf16_f32 v170, v148, v149
    v_exp_f32 v151, v151
    buffer_load_dwordx4 v248, s[20:23], s52 offen offset:2048 lds
    v_cvt_pk_bf16_f32 v171, v150, v151
    s_nop 1
    v_mfma_f32_16x16x32_bf16 v[48:51], a[148:151], v[168:171], v[48:51]
    ds_read_b64_tr_b16 a[172:173], v243 offset:33888
    ds_read_b64_tr_b16 a[174:175], v243 offset:34144
    v_mfma_f32_16x16x32_bf16 v[48:51], a[144:147], v[156:159], v[48:51]
    buffer_load_dwordx4 v249, s[20:23], s52 offen offset:3072 lds
    v_mfma_f32_16x16x32_bf16 v[80:83], a[144:147], v[160:163], v[80:83]
    s_add_u32 s52, s52, 32768
    v_exp_f32 v96, v96
    v_mfma_f32_16x16x32_bf16 v[84:87], a[152:155], v[160:163], v[84:87]
    s_add_u32 m0, s77, 134656
    v_exp_f32 v97, v97
    v_mfma_f32_16x16x32_bf16 v[52:55], a[152:155], v[156:159], v[52:55]
    buffer_load_dwordx4 v246, s[20:23], s52 offen offset:0 lds
    v_mfma_f32_16x16x32_bf16 v[52:55], a[156:159], v[168:171], v[52:55]
    ds_read_b64_tr_b16 a[128:129], v240 offset:33792
    v_cvt_pk_bf16_f32 v172, v96, v97
    v_mfma_f32_16x16x32_bf16 v[20:23], a[156:159], v[164:167], v[20:23]
    v_exp_f32 v98, v98
    v_mfma_f32_16x16x32_bf16 v[20:23], a[152:155], v[152:155], v[20:23]
    buffer_load_dwordx4 v247, s[20:23], s52 offen offset:1024 lds
    v_mfma_f32_16x16x32_bf16 v[24:27], a[160:163], v[152:155], v[24:27]
    s_waitcnt lgkmcnt(1)
    v_exp_f32 v99, v99
    v_mfma_f32_16x16x32_bf16 v[24:27], a[164:167], v[164:167], v[24:27]
    ds_read_b64_tr_b16 a[130:131], v240 offset:34048
    v_cvt_pk_bf16_f32 v173, v98, v99
    v_mfma_f32_16x16x32_bf16 v[56:59], a[164:167], v[168:171], v[56:59]
    buffer_load_dwordx4 v248, s[20:23], s52 offen offset:2048 lds
    v_mfma_f32_16x16x32_bf16 v[56:59], a[160:163], v[156:159], v[56:59]
    v_exp_f32 v100, v100
    v_mfma_f32_16x16x32_bf16 v[88:91], a[160:163], v[160:163], v[88:91]
    v_exp_f32 v101, v101
    v_mfma_f32_16x16x32_bf16 v[92:95], a[168:171], v[160:163], v[92:95]
    buffer_load_dwordx4 v249, s[20:23], s52 offen offset:3072 lds
    v_mfma_f32_16x16x32_bf16 v[60:63], a[168:171], v[156:159], v[60:63]
    buffer_load_dword v230, off, s[24:27], s59
    v_mfma_f32_16x16x32_bf16 v[60:63], a[172:175], v[168:171], v[60:63]
    s_add_u32 s52, s52, 32768
    ds_read_b64_tr_b16 a[136:137], v242 offset:33792
    v_cvt_pk_bf16_f32 v174, v100, v101
    v_mfma_f32_16x16x32_bf16 v[28:31], a[172:175], v[164:167], v[28:31]
    s_add_u32 m0, s77, 50688
    v_exp_f32 v102, v102
    v_mfma_f32_16x16x32_bf16 v[28:31], a[168:171], v[152:155], v[28:31]
    s_waitcnt vmcnt(9)
    v_exp_f32 v103, v103
    v_mfma_f32_16x16x32_bf16 v[212:215], v[224:227], v[152:155], v[212:215]
    s_barrier
    ds_read_b64_tr_b16 a[176:177], v241 offset:50688
    ds_read_b64_tr_b16 a[178:179], v241 offset:50944
    v_mfma_f32_16x16x32_bf16 v[212:215], v[224:227], v[164:167], v[212:215]
    ds_read_b64_tr_b16 a[180:181], v243 offset:50688
    ds_read_b64_tr_b16 a[182:183], v243 offset:50944
    v_mfma_f32_16x16x32_bf16 v[216:219], v[224:227], v[156:159], v[216:219]
    ds_read_b64_tr_b16 a[184:185], v241 offset:50720
    v_cvt_pk_bf16_f32 v175, v102, v103
    v_mfma_f32_16x16x32_bf16 v[216:219], v[224:227], v[168:171], v[216:219]
    v_exp_f32 v120, v120
    v_mfma_f32_16x16x32_bf16 v[220:223], v[224:227], v[160:163], v[220:223]
    v_exp_f32 v121, v121
    v_mfma_f32_16x16x32_bf16 v[212:215], v[224:227], v[172:175], v[212:215]
    ds_read_b64_tr_b16 a[186:187], v241 offset:50976
    v_cvt_pk_bf16_f32 v184, v120, v121
    v_exp_f32 v122, v122
    v_exp_f32 v123, v123
    v_exp_f32 v124, v124
    v_cvt_pk_bf16_f32 v185, v122, v123
    v_exp_f32 v125, v125
    v_exp_f32 v126, v126
    v_cvt_pk_bf16_f32 v186, v124, v125
    v_exp_f32 v127, v127
    buffer_load_dwordx4 v246, s[20:23], s52 offen offset:0 lds
    v_cvt_pk_bf16_f32 v187, v126, v127
    s_nop 1
    v_mfma_f32_16x16x32_bf16 v[212:215], v[224:227], v[184:187], v[212:215]
    v_exp_f32 v104, v104
    v_exp_f32 v105, v105
    v_exp_f32 v106, v106
    v_cvt_pk_bf16_f32 v176, v104, v105
    v_exp_f32 v107, v107
    v_exp_f32 v108, v108
    v_cvt_pk_bf16_f32 v177, v106, v107
    v_exp_f32 v109, v109
    v_exp_f32 v110, v110
    v_cvt_pk_bf16_f32 v178, v108, v109
    v_exp_f32 v111, v111
    buffer_load_dwordx4 v247, s[20:23], s52 offen offset:1024 lds
    v_cvt_pk_bf16_f32 v179, v110, v111
    s_nop 1
    v_mfma_f32_16x16x32_bf16 v[216:219], v[224:227], v[176:179], v[216:219]
    v_exp_f32 v128, v128
    v_exp_f32 v129, v129
    v_exp_f32 v130, v130
    v_cvt_pk_bf16_f32 v188, v128, v129
    v_exp_f32 v131, v131
    v_exp_f32 v132, v132
    v_cvt_pk_bf16_f32 v189, v130, v131
    v_exp_f32 v133, v133
    v_exp_f32 v134, v134
    v_cvt_pk_bf16_f32 v190, v132, v133
    v_exp_f32 v135, v135
    buffer_load_dwordx4 v248, s[20:23], s52 offen offset:2048 lds
    v_cvt_pk_bf16_f32 v191, v134, v135
    s_nop 1
    v_mfma_f32_16x16x32_bf16 v[216:219], v[224:227], v[188:191], v[216:219]
    v_exp_f32 v112, v112
    v_exp_f32 v113, v113
    v_exp_f32 v114, v114
    v_cvt_pk_bf16_f32 v180, v112, v113
    v_exp_f32 v115, v115
    v_exp_f32 v116, v116
    v_cvt_pk_bf16_f32 v181, v114, v115
    v_exp_f32 v117, v117
    v_exp_f32 v118, v118
    v_cvt_pk_bf16_f32 v182, v116, v117
    v_exp_f32 v119, v119
    buffer_load_dwordx4 v249, s[20:23], s52 offen offset:3072 lds
    v_cvt_pk_bf16_f32 v183, v118, v119
    s_nop 1
    v_mfma_f32_16x16x32_bf16 v[220:223], v[224:227], v[180:183], v[220:223]
    s_waitcnt lgkmcnt(0)
    ds_read_b64_tr_b16 a[188:189], v243 offset:50720
    ds_read_b64_tr_b16 a[190:191], v243 offset:50976
    v_mfma_f32_16x16x32_bf16 v[16:19], a[176:179], v[172:175], v[16:19]
    s_add_u32 s52, s52, 32768
    ds_read_b64_tr_b16 a[192:193], v241 offset:50752
    ds_read_b64_tr_b16 a[194:195], v241 offset:51008
    v_mfma_f32_16x16x32_bf16 v[16:19], a[180:183], v[184:187], v[16:19]
    s_add_u32 m0, s77, 67584
    ds_read_b64_tr_b16 a[196:197], v243 offset:50752
    ds_read_b64_tr_b16 a[198:199], v243 offset:51008
    v_mfma_f32_16x16x32_bf16 v[48:51], a[180:183], v[188:191], v[48:51]
    buffer_load_dwordx4 v246, s[20:23], s52 offen offset:0 lds
    v_mfma_f32_16x16x32_bf16 v[48:51], a[176:179], v[176:179], v[48:51]
    ds_read_b64_tr_b16 a[200:201], v241 offset:50784
    ds_read_b64_tr_b16 a[202:203], v241 offset:51040
    v_mfma_f32_16x16x32_bf16 v[80:83], a[176:179], v[180:183], v[80:83]
    buffer_load_dwordx4 v247, s[20:23], s52 offen offset:1024 lds
    v_mfma_f32_16x16x32_bf16 v[84:87], a[184:187], v[180:183], v[84:87]
    v_rcp_f32 v193, v212
    v_mfma_f32_16x16x32_bf16 v[52:55], a[184:187], v[176:179], v[52:55]
    s_waitcnt lgkmcnt(5)
    v_rcp_f32 v194, v216
    v_mfma_f32_16x16x32_bf16 v[52:55], a[188:191], v[188:191], v[52:55]
    ds_read_b64_tr_b16 a[204:205], v243 offset:50784
    ds_read_b64_tr_b16 a[206:207], v243 offset:51040
    v_mfma_f32_16x16x32_bf16 v[20:23], a[188:191], v[184:187], v[20:23]
    buffer_load_dwordx4 v248, s[20:23], s52 offen offset:2048 lds
    v_mfma_f32_16x16x32_bf16 v[20:23], a[184:187], v[172:175], v[20:23]
    s_waitcnt lgkmcnt(3)
    v_mul_f32 v16, v193, v16
    v_mul_f32 v17, v193, v17
    v_mfma_f32_16x16x32_bf16 v[24:27], a[192:195], v[172:175], v[24:27]
    buffer_load_dwordx4 v249, s[20:23], s52 offen offset:3072 lds
    v_mfma_f32_16x16x32_bf16 v[24:27], a[196:199], v[184:187], v[24:27]
    s_add_u32 s52, s80, 2
    ds_read_b64_tr_b16 a[132:133], v240 offset:50688
    ds_read_b64_tr_b16 a[134:135], v240 offset:50944
    v_mfma_f32_16x16x32_bf16 v[56:59], a[196:199], v[188:191], v[56:59]
    s_and_b32 s52, s52, 3
    ds_read_b64_tr_b16 a[138:139], v242 offset:34048
    v_mul_f32 v18, v193, v18
    v_mfma_f32_16x16x32_bf16 v[56:59], a[192:195], v[176:179], v[56:59]
    s_lshl_b32 s52, s52, 18
    ds_read_b64_tr_b16 a[140:141], v242 offset:50688
    ds_read_b64_tr_b16 a[142:143], v242 offset:50944
    v_mfma_f32_16x16x32_bf16 v[88:91], a[192:195], v[180:183], v[88:91]
    s_waitcnt lgkmcnt(5)
    v_mul_f32 v19, v193, v19
    v_mul_f32 v20, v193, v20
    v_mfma_f32_16x16x32_bf16 v[92:95], a[200:203], v[180:183], v[92:95]
    s_add_u32 s52, s52, s76
    v_mul_f32 v21, v193, v21
    v_mul_f32 v22, v193, v22
    v_mfma_f32_16x16x32_bf16 v[60:63], a[200:203], v[176:179], v[60:63]
    s_add_u32 m0, s77, 118272
    v_mul_f32 v23, v193, v23
    v_cvt_pk_bf16_f32 v16, v16, v17
    v_mfma_f32_16x16x32_bf16 v[60:63], a[204:207], v[188:191], v[60:63]
    v_cvt_pk_bf16_f32 v17, v18, v19
    v_mul_f32 v48, v194, v48
    v_mfma_f32_16x16x32_bf16 v[28:31], a[204:207], v[184:187], v[28:31]
    v_cvt_pk_bf16_f32 v18, v20, v21
    v_cvt_pk_bf16_f32 v19, v22, v23
    v_mfma_f32_16x16x32_bf16 v[28:31], a[200:203], v[172:175], v[28:31]
    buffer_store_dwordx4 v[16:19], v254, s[24:27], s3 offen offset:0 sc1
    v_mfma_f32_16x16x32_bf16 v[0:3], a[128:131], v[152:155], v[0:3]
    s_waitcnt lgkmcnt(0)
    ds_read_b64_tr_b16 a[144:145], v240 offset:50720
    ds_read_b64_tr_b16 a[146:147], v240 offset:50976
    v_mfma_f32_16x16x32_bf16 v[0:3], a[132:135], v[172:175], v[0:3]
    ds_read_b64_tr_b16 a[148:149], v240 offset:33824
    ds_read_b64_tr_b16 a[150:151], v240 offset:34080
    v_mfma_f32_16x16x32_bf16 v[0:3], a[136:139], v[164:167], v[0:3]
    v_mul_f32 v49, v194, v49
    v_mul_f32 v50, v194, v50
    v_mfma_f32_16x16x32_bf16 v[0:3], a[140:143], v[184:187], v[0:3]
    v_mul_f32 v51, v194, v51
    v_mul_f32 v52, v194, v52
    v_mfma_f32_16x16x32_bf16 v[32:35], a[140:143], v[188:191], v[32:35]
    ds_read_b64_tr_b16 a[152:153], v242 offset:33824
    ds_read_b64_tr_b16 a[154:155], v242 offset:34080
    v_mfma_f32_16x16x32_bf16 v[32:35], a[136:139], v[168:171], v[32:35]
    ds_read_b64_tr_b16 a[156:157], v242 offset:50720
    ds_read_b64_tr_b16 a[158:159], v242 offset:50976
    v_mfma_f32_16x16x32_bf16 v[32:35], a[132:135], v[176:179], v[32:35]
    v_mul_f32 v53, v194, v53
    v_mul_f32 v54, v194, v54
    v_mfma_f32_16x16x32_bf16 v[32:35], a[128:131], v[156:159], v[32:35]
    v_mul_f32 v55, v194, v55
    v_cvt_pk_bf16_f32 v48, v48, v49
    v_mfma_f32_16x16x32_bf16 v[64:67], a[128:131], v[160:163], v[64:67]
    v_cvt_pk_bf16_f32 v49, v50, v51
    v_mul_f32 v24, v193, v24
    v_mfma_f32_16x16x32_bf16 v[64:67], a[132:135], v[180:183], v[64:67]
    s_waitcnt lgkmcnt(4)
    v_cvt_pk_bf16_f32 v50, v52, v53
    v_cvt_pk_bf16_f32 v51, v54, v55
    v_mfma_f32_16x16x32_bf16 v[68:71], a[144:147], v[180:183], v[68:71]
    ds_read_b64_tr_b16 a[160:161], v240 offset:33856
    ds_read_b64_tr_b16 a[162:163], v240 offset:34112
    v_mfma_f32_16x16x32_bf16 v[68:71], a[148:151], v[160:163], v[68:71]
    ds_read_b64_tr_b16 a[164:165], v240 offset:50752
    ds_read_b64_tr_b16 a[166:167], v240 offset:51008
    v_mfma_f32_16x16x32_bf16 v[36:39], a[148:151], v[156:159], v[36:39]
    ds_write_b128 v239, v[80:83] offset:0
    v_mfma_f32_16x16x32_bf16 v[36:39], a[144:147], v[176:179], v[36:39]
    s_waitcnt lgkmcnt(5)
    ds_write_b128 v239, v[84:87] offset:1024
    v_mfma_f32_16x16x32_bf16 v[36:39], a[152:155], v[168:171], v[36:39]
    ds_write_b128 v239, v[88:91] offset:2048
    v_mfma_f32_16x16x32_bf16 v[36:39], a[156:159], v[188:191], v[36:39]
    ds_write_b128 v239, v[92:95] offset:3072
    v_mfma_f32_16x16x32_bf16 v[4:7], a[156:159], v[184:187], v[4:7]
    ds_write_b32 v236, v220 offset:0
    v_mfma_f32_16x16x32_bf16 v[4:7], a[152:155], v[164:167], v[4:7]
    ds_read_b64_tr_b16 a[168:169], v242 offset:33856
    ds_read_b64_tr_b16 a[170:171], v242 offset:34112
    v_mfma_f32_16x16x32_bf16 v[4:7], a[144:147], v[172:175], v[4:7]
    ds_read_b64_tr_b16 a[172:173], v242 offset:50752
    ds_read_b64_tr_b16 a[174:175], v242 offset:51008
    v_mfma_f32_16x16x32_bf16 v[4:7], a[148:151], v[152:155], v[4:7]
    s_waitcnt lgkmcnt(7)
    buffer_store_dwordx4 v[48:51], v254, s[24:27], s3 offen offset:2048 sc1
    v_mfma_f32_16x16x32_bf16 v[8:11], a[160:163], v[152:155], v[8:11]
    v_mul_f32 v25, v193, v25
    v_mul_f32 v26, v193, v26
    v_mfma_f32_16x16x32_bf16 v[8:11], a[164:167], v[172:175], v[8:11]
    ds_read_b64_tr_b16 a[176:177], v240 offset:50784
    ds_read_b64_tr_b16 a[178:179], v240 offset:51040
    v_mul_f32 v27, v193, v27
    v_mul_f32 v28, v193, v28
    v_mul_f32 v29, v193, v29
    v_mul_f32 v30, v193, v30
    v_mul_f32 v31, v193, v31
    v_cvt_pk_bf16_f32 v24, v24, v25
    v_cvt_pk_bf16_f32 v25, v26, v27
    v_cvt_pk_bf16_f32 v26, v28, v29
    v_cvt_pk_bf16_f32 v27, v30, v31
    buffer_store_dwordx4 v[24:27], v254, s[24:27], s3 offen offset:1024 sc1
    v_mul_f32 v56, v194, v56
    v_mul_f32 v57, v194, v57
    v_mul_f32 v58, v194, v58
    v_mul_f32 v59, v194, v59
    v_mul_f32 v60, v194, v60
    v_mul_f32 v61, v194, v61
    v_mul_f32 v62, v194, v62
    v_mul_f32 v63, v194, v63
    v_cvt_pk_bf16_f32 v56, v56, v57
    v_cvt_pk_bf16_f32 v57, v58, v59
    v_cvt_pk_bf16_f32 v58, v60, v61
    v_cvt_pk_bf16_f32 v59, v62, v63
    buffer_store_dwordx4 v[56:59], v254, s[24:27], s3 offen offset:3072 sc1
    s_waitcnt lgkmcnt(4)
    v_mfma_f32_16x16x32_bf16 v[8:11], a[168:171], v[164:167], v[8:11]
    s_waitcnt lgkmcnt(0)
    s_barrier
    v_mfma_f32_16x16x32_bf16 v[8:11], a[172:175], v[184:187], v[8:11]
    ds_read_b32 v192, v235 offset:0
    ds_read_b128 v[136:139], v238 offset:0
    v_mfma_f32_16x16x32_bf16 v[40:43], a[172:175], v[188:191], v[40:43]
    ds_read_b128 v[140:143], v238 offset:1024
    ds_read_b128 v[144:147], v238 offset:2048
    v_mfma_f32_16x16x32_bf16 v[40:43], a[168:171], v[168:171], v[40:43]
    v_mul_f32 v0, v193, v0
    v_mul_f32 v1, v193, v1
    v_mfma_f32_16x16x32_bf16 v[40:43], a[164:167], v[176:179], v[40:43]
    v_mul_f32 v2, v193, v2
    v_mul_f32 v3, v193, v3
    v_mfma_f32_16x16x32_bf16 v[40:43], a[160:163], v[156:159], v[40:43]
    v_mul_f32 v4, v193, v4
    v_mul_f32 v5, v193, v5
    v_mul_f32 v6, v193, v6
    v_mul_f32 v7, v193, v7
    v_cvt_pk_bf16_f32 v0, v0, v1
    v_cvt_pk_bf16_f32 v1, v2, v3
    v_cvt_pk_bf16_f32 v2, v4, v5
    v_cvt_pk_bf16_f32 v3, v6, v7
    buffer_store_dwordx4 v[0:3], v254, s[24:27], s56 offen offset:0 sc1
    v_mul_f32 v32, v194, v32
    v_mul_f32 v33, v194, v33
    v_mul_f32 v34, v194, v34
    v_mul_f32 v35, v194, v35
    v_mul_f32 v36, v194, v36
    v_mul_f32 v37, v194, v37
    v_mul_f32 v38, v194, v38
    s_waitcnt lgkmcnt(0)
    v_add_f32 v72, v72, v144
    v_add_f32 v73, v73, v145
    v_add_f32 v74, v74, v146
    v_add_f32 v75, v75, v147
    s_nop 1
    v_mfma_f32_16x16x32_bf16 v[72:75], a[160:163], v[160:163], v[72:75]
    v_mul_f32 v39, v194, v39
    v_cvt_pk_bf16_f32 v32, v32, v33
    v_mfma_f32_16x16x32_bf16 v[72:75], a[164:167], v[180:183], v[72:75]
    ds_read_b128 v[148:151], v238 offset:3072
    v_cvt_pk_bf16_f32 v33, v34, v35
    v_cvt_pk_bf16_f32 v34, v36, v37
    v_cvt_pk_bf16_f32 v35, v38, v39
    buffer_store_dwordx4 v[32:35], v254, s[24:27], s56 offen offset:2048 sc1
    ds_read_b64_tr_b16 a[180:181], v240 offset:33888
    ds_read_b64_tr_b16 a[182:183], v240 offset:34144
    ds_read_b64_tr_b16 a[184:185], v242 offset:33888
    ds_read_b64_tr_b16 a[186:187], v242 offset:34144
    ds_read_b64_tr_b16 a[188:189], v242 offset:50784
    ds_read_b64_tr_b16 a[190:191], v242 offset:51040
    v_add_f32 v220, v220, v192
    v_rcp_f32 v195, v220
    v_add_f32 v64, v64, v136
    v_mul_f32 v64, v195, v64
    v_add_f32 v65, v65, v137
    v_mul_f32 v65, v195, v65
    v_cvt_pk_bf16_f32 v64, v64, v65
    v_add_f32 v66, v66, v138
    v_mul_f32 v66, v195, v66
    v_add_f32 v67, v67, v139
    s_waitcnt lgkmcnt(6)
    v_add_f32 v76, v76, v148
    v_add_f32 v77, v77, v149
    v_add_f32 v78, v78, v150
    v_add_f32 v79, v79, v151
    s_nop 1
    v_mfma_f32_16x16x32_bf16 v[76:79], a[176:179], v[180:183], v[76:79]
    s_waitcnt lgkmcnt(4)
    v_mul_f32 v67, v195, v67
    v_add_f32 v68, v68, v140
    v_mfma_f32_16x16x32_bf16 v[76:79], a[180:183], v[160:163], v[76:79]
    v_mul_f32 v68, v195, v68
    v_cvt_pk_bf16_f32 v65, v66, v67
    v_mfma_f32_16x16x32_bf16 v[44:47], a[180:183], v[156:159], v[44:47]
    v_add_f32 v69, v69, v141
    v_add_f32 v70, v70, v142
    v_mfma_f32_16x16x32_bf16 v[44:47], a[176:179], v[176:179], v[44:47]
    s_waitcnt lgkmcnt(0)
    v_mul_f32 v69, v195, v69
    v_mul_f32 v70, v195, v70
    v_mfma_f32_16x16x32_bf16 v[44:47], a[184:187], v[168:171], v[44:47]
    v_cvt_pk_bf16_f32 v66, v68, v69
    v_add_f32 v71, v71, v143
    v_mfma_f32_16x16x32_bf16 v[44:47], a[188:191], v[188:191], v[44:47]
    v_mul_f32 v71, v195, v71
    v_max3_f32 v196, v193, v194, v195
    v_mfma_f32_16x16x32_bf16 v[12:15], a[188:191], v[184:187], v[12:15]
    v_cvt_pk_bf16_f32 v67, v70, v71
    v_add_f32 v197, v212, v216
    v_mfma_f32_16x16x32_bf16 v[12:15], a[184:187], v[164:167], v[12:15]
    buffer_store_dwordx4 v[64:67], v254, s[24:27], s57 offen offset:0 sc1
    v_mfma_f32_16x16x32_bf16 v[12:15], a[176:179], v[172:175], v[12:15]
    ds_write_b128 v237, v[16:19] offset:0
    v_mfma_f32_16x16x32_bf16 v[12:15], a[180:183], v[152:155], v[12:15]
    v_pk_mul_f32 v[8:9], v[8:9], v[192:193] op_sel:[0,1] op_sel_hi:[1,1]
    v_pk_mul_f32 v[10:11], v[10:11], v[192:193] op_sel:[0,1] op_sel_hi:[1,1]
    v_cvt_pk_bf16_f32 v8, v8, v9
    v_cvt_pk_bf16_f32 v9, v10, v11
    v_pk_mul_f32 v[40:41], v[40:41], v[194:195] op_sel:[0,0] op_sel_hi:[1,0]
    v_pk_mul_f32 v[42:43], v[42:43], v[194:195] op_sel:[0,0] op_sel_hi:[1,0]
    v_pk_mul_f32 v[44:45], v[44:45], v[194:195] op_sel:[0,0] op_sel_hi:[1,0]
    v_pk_mul_f32 v[46:47], v[46:47], v[194:195] op_sel:[0,0] op_sel_hi:[1,0]
    v_pk_mul_f32 v[12:13], v[12:13], v[192:193] op_sel:[0,1] op_sel_hi:[1,1]
    v_pk_mul_f32 v[14:15], v[14:15], v[192:193] op_sel:[0,1] op_sel_hi:[1,1]
    v_cvt_pk_bf16_f32 v10, v12, v13
    v_cvt_pk_bf16_f32 v11, v14, v15
    buffer_store_dwordx4 v[8:11], v254, s[24:27], s56 offen offset:1024 sc1
    ds_write_b128 v237, v[48:51] offset:2048
    ds_write_b128 v237, v[24:27] offset:1024
    ds_write_b128 v237, v[56:59] offset:3072
    ds_write_b128 v237, v[0:3] offset:4096
    ds_write_b128 v237, v[32:35] offset:6144
    v_cvt_pk_bf16_f32 v40, v40, v41
    v_cvt_pk_bf16_f32 v41, v42, v43
    v_cvt_pk_bf16_f32 v42, v44, v45
    v_cvt_pk_bf16_f32 v43, v46, v47
    buffer_store_dwordx4 v[40:43], v254, s[24:27], s56 offen offset:3072 sc1
    ds_write_b128 v237, v[64:67] offset:8192
    v_pk_mul_f32 v[72:73], v[72:73], v[194:195] op_sel:[0,1] op_sel_hi:[1,1]
    v_pk_mul_f32 v[74:75], v[74:75], v[194:195] op_sel:[0,1] op_sel_hi:[1,1]
    v_pk_mul_f32 v[76:77], v[76:77], v[194:195] op_sel:[0,1] op_sel_hi:[1,1]
    v_pk_mul_f32 v[78:79], v[78:79], v[194:195] op_sel:[0,1] op_sel_hi:[1,1]
    v_cvt_pk_bf16_f32 v72, v72, v73
    v_cvt_pk_bf16_f32 v73, v74, v75
    v_cvt_pk_bf16_f32 v74, v76, v77
    v_cvt_pk_bf16_f32 v75, v78, v79
    buffer_store_dwordx4 v[72:75], v254, s[24:27], s57 offen offset:1024 sc1
    ds_write_b128 v237, v[8:11] offset:5120
    ds_write_b128 v237, v[40:43] offset:7168
    ds_write_b128 v237, v[72:75] offset:9216
    v_add_f32 v196, v196, v220
    v_add_f32 v196, v196, v197
    v_cmp_nge_f32 vcc, 0x4e800000, v196
    v_add_u32 v180, s65, v254
    s_cmp_lg_u64 vcc, 0
    s_cselect_b32 s66, 1, 0
    v_mov_b32 v197, s66
    ds_write_b32 v198, v197 offset:0
    v_mov_b32 v187, 162304
    v_readfirstlane_b32 s45, v228
    v_and_b32 v192, 3, v255
    v_max_u32 v192, 1, v192
    v_add_u32 v192, s80, v192
    v_and_b32 v192, 3, v192
    v_lshl_add_u32 v184, v192, 12, s67
    v_lshl_add_u32 v186, v192, 4, s59
    s_lshl_b32 s67, s80, 4
    s_waitcnt lgkmcnt(0)
    s_barrier
    ds_read_b128 a[128:131], v180 offset:4096
    ds_read_b128 a[132:135], v180 offset:5120
    ds_read_b128 a[136:139], v180 offset:0
    ds_read_b128 a[140:143], v180 offset:1024
    ds_read_b128 v[188:191], v187 offset:0
    s_waitcnt vmcnt(23)
    ds_read_b64_tr_b16 a[64:65], v231 offset:0
    ds_read_b64_tr_b16 a[66:67], v231 offset:2048
    ds_read_b64_tr_b16 a[68:69], v232 offset:0
    ds_read_b64_tr_b16 a[70:71], v232 offset:2048
    ds_read_b64_tr_b16 a[72:73], v233 offset:0
    ds_read_b64_tr_b16 a[74:75], v233 offset:2048
    ds_read_b64_tr_b16 a[76:77], v234 offset:0
    ds_read_b64_tr_b16 a[78:79], v234 offset:2048
    s_waitcnt vmcnt(19)
    ds_read_b64_tr_b16 a[80:81], v231 offset:16384
    ds_read_b64_tr_b16 a[82:83], v231 offset:18432
    ds_read_b64_tr_b16 a[84:85], v232 offset:16384
    ds_read_b64_tr_b16 a[86:87], v232 offset:18432
    ds_read_b64_tr_b16 a[88:89], v233 offset:16384
    ds_read_b64_tr_b16 a[90:91], v233 offset:18432
    ds_read_b64_tr_b16 a[92:93], v234 offset:16384
    ds_read_b64_tr_b16 a[94:95], v234 offset:18432
    ds_read_b128 a[144:147], v180 offset:6144
    ds_read_b128 a[148:151], v180 offset:7168
    ds_read_b128 a[152:155], v180 offset:2048
    s_waitcnt lgkmcnt(14)
    v_mfma_f32_16x16x32_bf16 v[96:99], a[0:3], a[128:131], 0
    s_waitcnt vmcnt(14)
    v_or3_b32 v188, v188, v189, v190
    v_subrev_u32 v176, 67584, v231
    v_mfma_f32_16x16x32_bf16 v[96:99], a[16:19], a[132:135], v[96:99]
    s_waitcnt vmcnt(10)
    v_or_b32 v188, v188, v191
    v_add_u32 v181, 84480, v180
    v_mfma_f32_16x16x32_bf16 v[96:99], a[32:35], a[136:139], v[96:99]
    v_readfirstlane_b32 s66, v188
    v_subrev_u32 v177, 67584, v232
    v_mfma_f32_16x16x32_bf16 v[96:99], a[48:51], a[140:143], v[96:99]
    s_cmp_gt_u32 s66, s79
    s_cbranch_scc1 L_fallback
    s_cmp_eq_u32 s45, 0
    s_cbranch_scc1 L_nonce
    L_nonce_ok:
    s_add_u32 s59, s59, s67
    v_subrev_u32 v178, 67584, v233
    v_mfma_f32_16x16x32_bf16 v[116:119], a[52:55], a[140:143], 0
    s_cmp_lt_u32 s60, 2
    s_cselect_b32 s65, 94720, 0
    s_cselect_b32 s67, 0, 151040
    s_add_u32 s65, s65, s67
    v_subrev_u32 v179, 67584, v234
    v_add_u32 v182, s65, v254
    v_mfma_f32_16x16x32_bf16 v[116:119], a[36:39], a[136:139], v[116:119]
    s_xor_b32 s65, s60, 2
    v_and_b32 v192, 15, v255
    v_lshrrev_b32 v194, 4, v255
    v_mfma_f32_16x16x32_bf16 v[116:119], a[20:23], a[132:135], v[116:119]
    s_mul_i32 s65, s65, 10240
    v_add_u32 v183, s65, v254
    v_lshl_or_b32 v193, v192, 1, 1
    v_mfma_f32_16x16x32_bf16 v[116:119], a[4:7], a[128:131], v[116:119]
    s_mul_i32 s67, s45, 0x9e3779b1
    v_mul_lo_u32 v193, s67, v193
    v_mfma_f32_16x16x32_bf16 v[136:139], a[8:11], a[128:131], 0
    s_waitcnt lgkmcnt(11)
    ds_read_b64_tr_b16 a[96:97], v176 offset:0
    ds_read_b64_tr_b16 a[98:99], v176 offset:2048
    v_mfma_f32_16x16x32_bf16 v[136:139], a[24:27], a[132:135], v[136:139]
    s_lshr_b32 s65, s60, 1
    ds_read_b128 a[156:159], v180 offset:3072
    v_lshrrev_b32 v193, 19, v193
    v_mfma_f32_16x16x32_bf16 v[136:139], a[40:43], a[136:139], v[136:139]
    s_mul_i32 s65, s65, 3072
    ds_read_b64_tr_b16 a[112:113], v176 offset:16896
    ds_read_b64_tr_b16 a[114:115], v176 offset:18944
    v_mfma_f32_16x16x32_bf16 v[136:139], a[56:59], a[140:143], v[136:139]
    s_lshl_b32 s67, s75, 9
    ds_read_b64_tr_b16 a[116:117], v177 offset:16896
    ds_read_b64_tr_b16 a[118:119], v177 offset:18944
    v_mfma_f32_16x16x32_bf16 v[156:159], a[60:63], a[140:143], 0
    s_waitcnt lgkmcnt(10)
    ds_read_b64_tr_b16 a[100:101], v177 offset:0
    ds_read_b64_tr_b16 a[102:103], v177 offset:2048
    v_mfma_f32_16x16x32_bf16 v[156:159], a[44:47], a[136:139], v[156:159]
    s_add_u32 s65, s65, s67
    ds_read_b64_tr_b16 a[104:105], v178 offset:0
    ds_read_b64_tr_b16 a[106:107], v178 offset:2048
    v_mfma_f32_16x16x32_bf16 v[156:159], a[28:31], a[132:135], v[156:159]
    s_lshr_b32 s68, s60, 1
    s_lshl_b32 s67, s75, 1
    s_add_u32 s68, s68, s67
    s_and_b32 s67, s41, 3
    s_cmp_eq_u32 s68, s67
    s_cselect_b32 s68, 268435456, 0
    ds_read_b64_tr_b16 a[120:121], v178 offset:16896
    ds_read_b64_tr_b16 a[122:123], v178 offset:18944
    v_mfma_f32_16x16x32_bf16 v[156:159], a[12:15], a[128:131], v[156:159]
    s_waitcnt lgkmcnt(12)
    ds_read_b64_tr_b16 a[124:125], v179 offset:16896
    ds_read_b64_tr_b16 a[126:127], v179 offset:18944
    v_mfma_f32_16x16x32_bf16 v[160:163], a[12:15], a[144:147], 0
    ds_read_b64_tr_b16 a[108:109], v179 offset:0
    ds_read_b64_tr_b16 a[110:111], v179 offset:2048
    v_mfma_f32_16x16x32_bf16 v[160:163], a[28:31], a[148:151], v[160:163]
    ds_read_b128 a[160:163], v180 offset:10240
    v_or_b32 v193, 16384, v193
    v_mfma_f32_16x16x32_bf16 v[160:163], a[44:47], a[152:155], v[160:163]
    s_waitcnt lgkmcnt(12)
    ds_read_b128 a[164:167], v180 offset:11264
    v_lshlrev_b32 v229, 16, v193
    v_mfma_f32_16x16x32_bf16 v[160:163], a[60:63], a[156:159], v[160:163]
    ds_read_b128 a[168:171], v180 offset:14336
    v_mul_u32_u24 v194, 6144, v194
    v_mfma_f32_16x16x32_bf16 v[140:143], a[56:59], a[156:159], 0
    ds_read_b128 a[172:175], v180 offset:15360
    v_lshl_add_u32 v195, v192, 4, s65
    v_mfma_f32_16x16x32_bf16 v[140:143], a[40:43], a[152:155], v[140:143]
    ds_read_b128 a[176:179], v180 offset:12288
    v_add_u32 v185, v194, v195
    v_mfma_f32_16x16x32_bf16 v[140:143], a[24:27], a[148:151], v[140:143]
    ds_read_b128 a[180:183], v180 offset:13312
    v_add_u32 v88, 84480, v195
    v_mfma_f32_16x16x32_bf16 v[140:143], a[8:11], a[144:147], v[140:143]
    s_waitcnt lgkmcnt(8)
    ds_read_b128 a[184:187], v180 offset:16384
    v_add_u32 v89, s68, v254
    v_mfma_f32_16x16x32_bf16 v[120:123], a[4:7], a[144:147], 0
    s_waitcnt vmcnt(0)
    buffer_store_dword v228, off, s[24:27], s59
    v_mfma_f32_16x16x32_bf16 v[120:123], a[20:23], a[148:151], v[120:123]
    buffer_load_dwordx4 v246, s[20:23], s52 offen offset:0 lds
    v_mfma_f32_16x16x32_bf16 v[120:123], a[36:39], a[152:155], v[120:123]
    buffer_load_dwordx4 v247, s[20:23], s52 offen offset:1024 lds
    v_mfma_f32_16x16x32_bf16 v[120:123], a[52:55], a[156:159], v[120:123]
    buffer_load_dwordx4 v248, s[20:23], s52 offen offset:2048 lds
    v_mfma_f32_16x16x32_bf16 v[100:103], a[48:51], a[156:159], 0
    buffer_load_dwordx4 v249, s[20:23], s52 offen offset:3072 lds
    v_mfma_f32_16x16x32_bf16 v[100:103], a[32:35], a[152:155], v[100:103]
    s_add_u32 s52, s52, 32768
    s_add_u32 m0, s77, 134656
    ds_read_b128 a[188:191], v180 offset:17408
    v_mfma_f32_16x16x32_bf16 v[100:103], a[16:19], a[148:151], v[100:103]
    buffer_load_dwordx4 v246, s[20:23], s52 offen offset:0 lds
    v_mfma_f32_16x16x32_bf16 v[100:103], a[0:3], a[144:147], v[100:103]
    s_waitcnt lgkmcnt(1)
    buffer_load_dwordx4 v247, s[20:23], s52 offen offset:1024 lds
    v_mfma_f32_16x16x32_bf16 v[104:107], a[0:3], a[160:163], 0
    buffer_load_dwordx4 v248, s[20:23], s52 offen offset:2048 lds
    v_mfma_f32_16x16x32_bf16 v[104:107], a[16:19], a[164:167], v[104:107]
    buffer_load_dwordx4 v249, s[20:23], s52 offen offset:3072 lds
    v_mfma_f32_16x16x32_bf16 v[104:107], a[32:35], a[168:171], v[104:107]
    s_add_u32 m0, s0, 0
    buffer_load_dword v230, v186, s[24:27], 0 offen offset:0 sc1
    v_mfma_f32_16x16x32_bf16 v[104:107], a[48:51], a[172:175], v[104:107]
    ds_read_b128 a[192:195], v180 offset:8192
    ds_read_b128 a[196:199], v180 offset:9216
    v_mfma_f32_16x16x32_bf16 v[124:127], a[52:55], a[172:175], 0
    s_add_u32 s52, s52, 32768
    ds_read_b128 a[200:203], v180 offset:18432
    ds_read_b128 a[204:207], v180 offset:19456
    v_mfma_f32_16x16x32_bf16 v[124:127], a[36:39], a[168:171], v[124:127]
    v_and_b32 v193, 1, v192
    v_mov_b32 v194, 0x3f80
    v_mfma_f32_16x16x32_bf16 v[124:127], a[20:23], a[164:167], v[124:127]
    v_lshlrev_b32 v193, 4, v193
    v_lshrrev_b32 v192, 1, v192
    v_mfma_f32_16x16x32_bf16 v[124:127], a[4:7], a[160:163], v[124:127]
    v_lshlrev_b32 v193, v193, v194
    v_and_b32 v91, 3, v255
    v_mfma_f32_16x16x32_bf16 v[144:147], a[8:11], a[160:163], 0
    v_max_u32 v91, 1, v91
    v_cvt_pk_bf16_f32 v19, 0, v229
    v_mfma_f32_16x16x32_bf16 v[144:147], a[24:27], a[164:167], v[144:147]
    v_add_u32 v91, s41, v91
    v_cvt_pk_bf16_f32 v43, 0, v229
    v_mfma_f32_16x16x32_bf16 v[144:147], a[40:43], a[168:171], v[144:147]
    v_and_b32 v91, 3, v91
    v_lshlrev_b32 v91, 7, v91
    v_mfma_f32_16x16x32_bf16 v[144:147], a[56:59], a[172:175], v[144:147]
    v_mfma_f32_16x16x32_bf16 v[164:167], a[60:63], a[172:175], 0
    v_mfma_f32_16x16x32_bf16 v[164:167], a[44:47], a[168:171], v[164:167]
    s_waitcnt lgkmcnt(0)
    s_barrier
    s_waitcnt vmcnt(0)
    v_cmp_ne_u32 vcc, s45, v230
    s_cbranch_vccnz L_spin
    L_spin_ok:
    v_mfma_f32_16x16x32_bf16 v[164:167], a[28:31], a[164:167], v[164:167]
    buffer_load_dwordx4 v254, s[24:27], s53 offen offset:0 sc1 lds
    v_mfma_f32_16x16x32_bf16 v[164:167], a[12:15], a[160:163], v[164:167]
    buffer_load_dwordx4 v254, s[24:27], s53 offen offset:1024 sc1 lds
    v_mfma_f32_16x16x32_bf16 v[168:171], a[12:15], a[176:179], 0
    buffer_load_dwordx4 v254, s[24:27], s53 offen offset:2048 sc1 lds
    v_mfma_f32_16x16x32_bf16 v[168:171], a[28:31], a[180:183], v[168:171]
    buffer_load_dwordx4 v254, s[24:27], s53 offen offset:3072 sc1 lds
    v_mfma_f32_16x16x32_bf16 v[168:171], a[44:47], a[184:187], v[168:171]
    s_add_u32 m0, s77, 50688
    buffer_store_dword v228, off, s[24:27], s47 sc1
    v_mfma_f32_16x16x32_bf16 v[168:171], a[60:63], a[188:191], v[168:171]
    buffer_load_dwordx4 v246, s[20:23], s52 offen offset:0 lds
    v_mfma_f32_16x16x32_bf16 v[148:151], a[56:59], a[188:191], 0
    buffer_load_dwordx4 v247, s[20:23], s52 offen offset:1024 lds
    v_mfma_f32_16x16x32_bf16 v[148:151], a[40:43], a[184:187], v[148:151]
    buffer_load_dwordx4 v248, s[20:23], s52 offen offset:2048 lds
    v_mfma_f32_16x16x32_bf16 v[148:151], a[24:27], a[180:183], v[148:151]
    buffer_load_dwordx4 v249, s[20:23], s52 offen offset:3072 lds
    v_mfma_f32_16x16x32_bf16 v[148:151], a[8:11], a[176:179], v[148:151]
    s_add_u32 s52, s52, 32768
    v_cmp_eq_u32 vcc, 0, v192
    v_mfma_f32_16x16x32_bf16 v[128:131], a[4:7], a[176:179], 0
    s_add_u32 m0, s77, 67584
    v_cndmask_b32 v80, 0, v193, vcc
    v_cmp_eq_u32 vcc, 1, v192
    v_mfma_f32_16x16x32_bf16 v[128:131], a[20:23], a[180:183], v[128:131]
    buffer_load_dwordx4 v246, s[20:23], s52 offen offset:0 lds
    v_mfma_f32_16x16x32_bf16 v[128:131], a[36:39], a[184:187], v[128:131]
    buffer_load_dwordx4 v247, s[20:23], s52 offen offset:1024 lds
    v_mfma_f32_16x16x32_bf16 v[128:131], a[52:55], a[188:191], v[128:131]
    buffer_load_dwordx4 v248, s[20:23], s52 offen offset:2048 lds
    v_mfma_f32_16x16x32_bf16 v[108:111], a[48:51], a[188:191], 0
    s_add_u32 s53, s53, 4096
    v_cndmask_b32 v81, 0, v193, vcc
    v_cmp_eq_u32 vcc, 2, v192
    v_mfma_f32_16x16x32_bf16 v[108:111], a[32:35], a[184:187], v[108:111]
    v_mfma_f32_16x16x32_bf16 v[108:111], a[16:19], a[180:183], v[108:111]
    v_cndmask_b32 v82, 0, v193, vcc
    v_cmp_eq_u32 vcc, 3, v192
    v_mfma_f32_16x16x32_bf16 v[108:111], a[0:3], a[176:179], v[108:111]
    s_lshl_b32 s72, s42, 4
    s_add_u32 s72, s72, s41
    s_lshl_b32 s72, s72, 7
    s_add_u32 s72, s72, 786432
    s_andn2_b32 s74, s72, 0x180
    s_lshl_b32 s65, s60, 28
    v_cndmask_b32 v83, 0, v193, vcc
    v_mov_b32 v90, s65
    v_mfma_f32_16x16x32_bf16 v[112:115], a[0:3], a[192:195], 0
    ds_read_b64_tr_b16 a[0:1], v231 offset:0
    v_cmp_eq_u32 vcc, 4, v192
    v_mfma_f32_16x16x32_bf16 v[112:115], a[16:19], a[196:199], v[112:115]
    ds_read_b64_tr_b16 a[2:3], v231 offset:2048
    ds_read_b64_tr_b16 a[16:17], v231 offset:16384
    v_mfma_f32_16x16x32_bf16 v[112:115], a[32:35], a[200:203], v[112:115]
    ds_read_b64_tr_b16 a[18:19], v231 offset:18432
    v_cndmask_b32 v84, 0, v193, vcc
    v_mfma_f32_16x16x32_bf16 v[112:115], a[48:51], a[204:207], v[112:115]
    v_cmp_eq_u32 vcc, 5, v192
    v_mfma_f32_16x16x32_bf16 v[132:135], a[52:55], a[204:207], 0
    v_mfma_f32_16x16x32_bf16 v[132:135], a[36:39], a[200:203], v[132:135]
    v_cndmask_b32 v85, 0, v193, vcc
    v_cmp_eq_u32 vcc, 6, v192
    v_mfma_f32_16x16x32_bf16 v[132:135], a[20:23], a[196:199], v[132:135]
    ds_read_b64_tr_b16 a[20:21], v232 offset:16384
    ds_read_b64_tr_b16 a[22:23], v232 offset:18432
    v_mfma_f32_16x16x32_bf16 v[132:135], a[4:7], a[192:195], v[132:135]
    buffer_load_dwordx4 v249, s[20:23], s52 offen offset:3072 lds
    s_add_u32 m0, s0, 4096
    s_add_u32 s52, s80, 3
    buffer_load_dwordx4 v254, s[24:27], s53 offen offset:0 sc1 lds
    buffer_load_dwordx4 v254, s[24:27], s53 offen offset:1024 sc1 lds
    s_waitcnt vmcnt(11)
    s_barrier
    ds_read_b128 a[208:211], v181 offset:0
    v_mfma_f32_16x16x32_bf16 v[152:155], a[8:11], a[192:195], 0
    s_and_b32 s52, s52, 3
    ds_read_b128 a[212:215], v181 offset:1024
    ds_read_b128 a[216:219], v181 offset:2048
    v_mfma_f32_16x16x32_bf16 v[152:155], a[24:27], a[196:199], v[152:155]
    buffer_load_dwordx4 v254, s[24:27], s53 offen offset:2048 sc1 lds
    v_mfma_f32_16x16x32_bf16 v[152:155], a[40:43], a[200:203], v[152:155]
    buffer_load_dwordx4 v254, s[24:27], s53 offen offset:3072 sc1 lds
    v_mfma_f32_16x16x32_bf16 v[152:155], a[56:59], a[204:207], v[152:155]
    s_add_u32 s53, s53, 4096
    ds_read_b128 a[220:223], v181 offset:3072
    ds_read_b128 a[224:227], v182 offset:0
    v_mfma_f32_16x16x32_bf16 v[172:175], a[60:63], a[204:207], 0
    s_add_u32 m0, s0, 8192
    ds_read_b128 a[228:231], v182 offset:1024
    v_cndmask_b32 v86, 0, v193, vcc
    v_mfma_f32_16x16x32_bf16 v[172:175], a[44:47], a[200:203], v[172:175]
    buffer_load_dwordx4 v254, s[24:27], s53 offen offset:0 sc1 lds
    v_mfma_f32_16x16x32_bf16 v[172:175], a[28:31], a[196:199], v[172:175]
    s_lshl_b32 s52, s52, 18
    ds_read_b128 a[232:235], v182 offset:2048
    ds_read_b128 a[236:239], v182 offset:3072
    v_mfma_f32_16x16x32_bf16 v[172:175], a[12:15], a[192:195], v[172:175]
    s_waitcnt lgkmcnt(6)
    ds_read_b64_tr_b16 a[4:5], v232 offset:0
    v_cmp_eq_u32 vcc, 7, v192
    v_mfma_f32_16x16x32_bf16 v[96:99], a[96:99], a[208:211], v[96:99]
    buffer_load_dwordx4 v254, s[24:27], s53 offen offset:1024 sc1 lds
    v_mfma_f32_16x16x32_bf16 v[96:99], a[112:115], a[212:215], v[96:99]
    s_add_u32 s53, s80, 2
    ds_read_b64_tr_b16 a[6:7], v232 offset:2048
    v_cndmask_b32 v87, 0, v193, vcc
    v_mfma_f32_16x16x32_bf16 v[116:119], a[116:119], a[212:215], v[116:119]
    s_and_b32 s53, s53, 3
    ds_read_b64_tr_b16 a[8:9], v233 offset:0
    ds_read_b64_tr_b16 a[10:11], v233 offset:2048
    v_mfma_f32_16x16x32_bf16 v[116:119], a[100:103], a[208:211], v[116:119]
    s_sub_u32 s53, s53, s80
    ds_read_b64_tr_b16 a[24:25], v233 offset:16384
    ds_read_b64_tr_b16 a[26:27], v233 offset:18432
    v_mfma_f32_16x16x32_bf16 v[136:139], a[104:107], a[208:211], v[136:139]
    s_mul_i32 s53, s53, 327680
    ds_read_b64_tr_b16 a[28:29], v234 offset:16384
    ds_read_b64_tr_b16 a[30:31], v234 offset:18432
    v_mfma_f32_16x16x32_bf16 v[136:139], a[120:123], a[212:215], v[136:139]
    s_add_u32 s53, s53, s3
    ds_read_b64_tr_b16 a[12:13], v234 offset:0
    ds_read_b64_tr_b16 a[14:15], v234 offset:2048
    v_mfma_f32_16x16x32_bf16 v[156:159], a[124:127], a[212:215], v[156:159]
    s_add_u32 m0, s1, 0
    s_add_u32 s52, s52, s76
    v_mfma_f32_16x16x32_bf16 v[156:159], a[108:111], a[208:211], v[156:159]
    s_waitcnt lgkmcnt(8)
    v_mfma_f32_16x16x32_bf16 v[160:163], a[108:111], a[216:219], v[160:163]
    buffer_load_dwordx4 v254, s[24:27], s53 offen offset:0 sc1 lds
    v_mfma_f32_16x16x32_bf16 v[160:163], a[124:127], a[220:223], v[160:163]
    buffer_load_dwordx4 v254, s[24:27], s53 offen offset:1024 sc1 lds
    v_mfma_f32_16x16x32_bf16 v[140:143], a[120:123], a[220:223], v[140:143]
    s_waitcnt vmcnt(12)
    ds_read_b64_tr_b16 a[32:33], v176 offset:0
    ds_read_b64_tr_b16 a[34:35], v176 offset:2048
    v_mfma_f32_16x16x32_bf16 v[140:143], a[104:107], a[216:219], v[140:143]
    s_waitcnt lgkmcnt(4)
    ds_read_b64_tr_b16 a[36:37], v177 offset:0
    ds_read_b64_tr_b16 a[38:39], v177 offset:2048
    v_mfma_f32_16x16x32_bf16 v[120:123], a[100:103], a[216:219], v[120:123]
    buffer_load_dwordx4 v254, s[24:27], s53 offen offset:2048 sc1 lds
    v_mfma_f32_16x16x32_bf16 v[120:123], a[116:119], a[220:223], v[120:123]
    s_waitcnt lgkmcnt(4)
    ds_read_b64_tr_b16 a[40:41], v178 offset:0
    ds_read_b64_tr_b16 a[42:43], v178 offset:2048
    v_mfma_f32_16x16x32_bf16 v[100:103], a[112:115], a[220:223], v[100:103]
    ds_read_b64_tr_b16 a[44:45], v179 offset:0
    ds_read_b64_tr_b16 a[46:47], v179 offset:2048
    v_mfma_f32_16x16x32_bf16 v[100:103], a[96:99], a[216:219], v[100:103]
    v_mfma_f32_16x16x32_bf16 v[104:107], a[64:67], a[224:227], v[104:107]
    buffer_load_dwordx4 v254, s[24:27], s53 offen offset:3072 sc1 lds
    v_mfma_f32_16x16x32_bf16 v[104:107], a[80:83], a[228:231], v[104:107]
    s_add_u32 s53, s53, 4096
    v_mfma_f32_16x16x32_bf16 v[124:127], a[84:87], a[228:231], v[124:127]
    s_add_u32 m0, s1, 4096
    v_mfma_f32_16x16x32_bf16 v[124:127], a[68:71], a[224:227], v[124:127]
    v_mfma_f32_16x16x32_bf16 v[144:147], a[72:75], a[224:227], v[144:147]
    buffer_load_dwordx4 v254, s[24:27], s53 offen offset:0 sc1 lds
    v_mfma_f32_16x16x32_bf16 v[144:147], a[88:91], a[228:231], v[144:147]
    s_waitcnt lgkmcnt(0)
    v_mfma_f32_16x16x32_bf16 v[164:167], a[92:95], a[228:231], v[164:167]
    v_mfma_f32_16x16x32_bf16 v[164:167], a[76:79], a[224:227], v[164:167]
    buffer_load_dwordx4 v254, s[24:27], s53 offen offset:1024 sc1 lds
    buffer_load_dwordx4 v254, s[24:27], s53 offen offset:2048 sc1 lds
    buffer_load_dwordx4 v254, s[24:27], s53 offen offset:3072 sc1 lds
    s_add_u32 s53, s53, 4096
    s_add_u32 m0, s1, 8192
    s_nop 0
    buffer_load_dwordx4 v254, s[24:27], s53 offen offset:0 sc1 lds
    s_waitcnt vmcnt(11)
    s_barrier
    ds_read_b128 a[240:243], v181 offset:4096
    v_mfma_f32_16x16x32_bf16 v[168:171], a[76:79], a[232:235], v[168:171]
    ds_read_b128 a[244:247], v181 offset:5120
    ds_read_b128 a[248:251], v181 offset:6144
    v_mfma_f32_16x16x32_bf16 v[168:171], a[92:95], a[236:239], v[168:171]
    buffer_load_dwordx4 v254, s[24:27], s53 offen offset:1024 sc1 lds
    v_mfma_f32_16x16x32_bf16 v[148:151], a[88:91], a[236:239], v[148:151]
    s_add_u32 m0, s77, 118272
    ds_read_b128 a[252:255], v181 offset:7168
    ds_read_b128 a[128:131], v182 offset:4096
    v_mfma_f32_16x16x32_bf16 v[148:151], a[72:75], a[232:235], v[148:151]
    s_add_u32 s53, s80, 3
    ds_read_b128 a[132:135], v182 offset:5120
    v_mfma_f32_16x16x32_bf16 v[128:131], a[68:71], a[232:235], v[128:131]
    s_and_b32 s53, s53, 3
    ds_read_b128 a[136:139], v182 offset:6144
    v_mfma_f32_16x16x32_bf16 v[128:131], a[84:87], a[236:239], v[128:131]
    s_sub_u32 s53, s53, s80
    ds_read_b128 a[140:143], v182 offset:7168
    v_mfma_f32_16x16x32_bf16 v[108:111], a[80:83], a[236:239], v[108:111]
    s_mul_i32 s53, s53, 327680
    ds_read_b64_tr_b16 a[48:49], v176 offset:16896
    v_mfma_f32_16x16x32_bf16 v[108:111], a[64:67], a[232:235], v[108:111]
    s_waitcnt lgkmcnt(7)
    ds_read_b64_tr_b16 a[50:51], v176 offset:18944
    ds_read_b64_tr_b16 a[52:53], v177 offset:16896
    v_mfma_f32_16x16x32_bf16 v[96:99], a[64:67], a[240:243], v[96:99]
    s_add_u32 s53, s53, s3
    ds_read_b64_tr_b16 a[54:55], v177 offset:18944
    ds_read_b64_tr_b16 a[56:57], v178 offset:16896
    v_mfma_f32_16x16x32_bf16 v[96:99], a[80:83], a[244:247], v[96:99]
    ds_read_b64_tr_b16 a[58:59], v178 offset:18944
    ds_read_b64_tr_b16 a[60:61], v179 offset:16896
    v_mfma_f32_16x16x32_bf16 v[116:119], a[84:87], a[244:247], v[116:119]
    ds_read_b64_tr_b16 a[62:63], v179 offset:18944
    v_mfma_f32_16x16x32_bf16 v[116:119], a[68:71], a[240:243], v[116:119]
    v_mfma_f32_16x16x32_bf16 v[136:139], a[72:75], a[240:243], v[136:139]
    v_mfma_f32_16x16x32_bf16 v[136:139], a[88:91], a[244:247], v[136:139]
    buffer_load_dwordx4 v246, s[20:23], s52 offen offset:0 lds
    v_mfma_f32_16x16x32_bf16 v[156:159], a[92:95], a[244:247], v[156:159]
    v_mfma_f32_16x16x32_bf16 v[156:159], a[76:79], a[240:243], v[156:159]
    s_waitcnt lgkmcnt(4)
    v_mfma_f32_16x16x32_bf16 v[160:163], a[76:79], a[248:251], v[160:163]
    v_mfma_f32_16x16x32_bf16 v[160:163], a[92:95], a[252:255], v[160:163]
    v_mfma_f32_16x16x32_bf16 v[140:143], a[88:91], a[252:255], v[140:143]
    s_waitcnt lgkmcnt(0)
    v_mfma_f32_16x16x32_bf16 v[140:143], a[72:75], a[248:251], v[140:143]
    v_mfma_f32_16x16x32_bf16 v[120:123], a[68:71], a[248:251], v[120:123]
    v_mfma_f32_16x16x32_bf16 v[120:123], a[84:87], a[252:255], v[120:123]
    v_mfma_f32_16x16x32_bf16 v[100:103], a[80:83], a[252:255], v[100:103]
    v_mfma_f32_16x16x32_bf16 v[100:103], a[64:67], a[248:251], v[100:103]
    v_mfma_f32_16x16x32_bf16 v[104:107], a[96:99], a[128:131], v[104:107]
    v_mfma_f32_16x16x32_bf16 v[104:107], a[112:115], a[132:135], v[104:107]
    v_mfma_f32_16x16x32_bf16 v[124:127], a[116:119], a[132:135], v[124:127]
    v_mfma_f32_16x16x32_bf16 v[124:127], a[100:103], a[128:131], v[124:127]
    buffer_load_dwordx4 v247, s[20:23], s52 offen offset:1024 lds
    v_mfma_f32_16x16x32_bf16 v[144:147], a[104:107], a[128:131], v[144:147]
    v_mfma_f32_16x16x32_bf16 v[144:147], a[120:123], a[132:135], v[144:147]
    s_waitcnt vmcnt(12)
    v_mfma_f32_16x16x32_bf16 v[164:167], a[124:127], a[132:135], v[164:167]
    s_barrier
    ds_read_b128 a[144:147], v181 offset:8192
    ds_read_b128 a[148:151], v181 offset:9216
    v_mfma_f32_16x16x32_bf16 v[164:167], a[108:111], a[128:131], v[164:167]
    buffer_load_dwordx4 v248, s[20:23], s52 offen offset:2048 lds
    v_mfma_f32_16x16x32_bf16 v[168:171], a[108:111], a[136:139], v[168:171]
    ds_read_b128 a[152:155], v182 offset:8192
    ds_read_b128 a[156:159], v182 offset:9216
    v_mfma_f32_16x16x32_bf16 v[168:171], a[124:127], a[140:143], v[168:171]
    v_mfma_f32_16x16x32_bf16 v[148:151], a[120:123], a[140:143], v[148:151]
    v_mfma_f32_16x16x32_bf16 v[148:151], a[104:107], a[136:139], v[148:151]
    buffer_load_dwordx4 v249, s[20:23], s52 offen offset:3072 lds
    v_mfma_f32_16x16x32_bf16 v[128:131], a[100:103], a[136:139], v[128:131]
    s_add_u32 s52, s52, 32768
    v_mfma_f32_16x16x32_bf16 v[128:131], a[116:119], a[140:143], v[128:131]
    s_add_u32 m0, s77, 134656
    v_mfma_f32_16x16x32_bf16 v[108:111], a[112:115], a[140:143], v[108:111]
    v_mfma_f32_16x16x32_bf16 v[108:111], a[96:99], a[136:139], v[108:111]
    s_waitcnt lgkmcnt(1)
    v_mfma_f32_16x16x32_bf16 v[112:115], a[64:67], a[144:147], v[112:115]
    buffer_load_dwordx4 v246, s[20:23], s52 offen offset:0 lds
    v_mfma_f32_16x16x32_bf16 v[112:115], a[80:83], a[148:151], v[112:115]
    s_waitcnt lgkmcnt(0)
    v_mfma_f32_16x16x32_bf16 v[112:115], a[96:99], a[152:155], v[112:115]
    s_barrier
    v_mfma_f32_16x16x32_bf16 v[112:115], a[112:115], a[156:159], v[112:115]
    buffer_load_dwordx4 v247, s[20:23], s52 offen offset:1024 lds
    v_mfma_f32_16x16x32_bf16 v[132:135], a[116:119], a[156:159], v[132:135]
    v_mfma_f32_16x16x32_bf16 v[132:135], a[100:103], a[152:155], v[132:135]
    v_mfma_f32_16x16x32_bf16 v[132:135], a[84:87], a[148:151], v[132:135]
    v_mfma_f32_16x16x32_bf16 v[132:135], a[68:71], a[144:147], v[132:135]
    buffer_load_dwordx4 v248, s[20:23], s52 offen offset:2048 lds
    buffer_load_dwordx4 v249, s[20:23], s52 offen offset:3072 lds
    s_add_u32 s52, s52, 32768
    s_add_u32 m0, s77, 50688
    s_nop 0
    buffer_load_dwordx4 v246, s[20:23], s52 offen offset:0 lds
    buffer_load_dwordx4 v247, s[20:23], s52 offen offset:1024 lds
    buffer_load_dwordx4 v248, s[20:23], s52 offen offset:2048 lds
    s_waitcnt vmcnt(11)
    s_barrier
    ds_read_b128 a[160:163], v180 offset:4096
    v_mfma_f32_16x16x32_bf16 v[152:155], a[72:75], a[144:147], v[152:155]
    ds_read_b128 a[164:167], v180 offset:5120
    ds_read_b128 a[168:171], v180 offset:0
    v_mfma_f32_16x16x32_bf16 v[152:155], a[88:91], a[148:151], v[152:155]
    ds_read_b128 a[172:175], v180 offset:1024
    v_mfma_f32_16x16x32_bf16 v[152:155], a[104:107], a[152:155], v[152:155]
    buffer_load_dwordx4 v249, s[20:23], s52 offen offset:3072 lds
    v_mfma_f32_16x16x32_bf16 v[152:155], a[120:123], a[156:159], v[152:155]
    s_add_u32 s52, s52, 32768
    ds_read_b128 a[176:179], v180 offset:6144
    ds_read_b128 a[180:183], v180 offset:7168
    v_mfma_f32_16x16x32_bf16 v[172:175], a[124:127], a[156:159], v[172:175]
    s_add_u32 m0, s77, 67584
    ds_read_b128 a[184:187], v180 offset:2048
    v_mfma_f32_16x16x32_bf16 v[172:175], a[108:111], a[152:155], v[172:175]
    buffer_load_dwordx4 v246, s[20:23], s52 offen offset:0 lds
    v_mfma_f32_16x16x32_bf16 v[172:175], a[92:95], a[148:151], v[172:175]
    ds_read_b128 a[188:191], v180 offset:3072
    ds_read_b128 a[192:195], v180 offset:10240
    v_mfma_f32_16x16x32_bf16 v[172:175], a[76:79], a[144:147], v[172:175]
    s_waitcnt lgkmcnt(7)
    ds_read_b128 a[196:199], v180 offset:11264
    v_mfma_f32_16x16x32_bf16 v[96:99], a[0:3], a[160:163], v[96:99]
    buffer_load_dwordx4 v247, s[20:23], s52 offen offset:1024 lds
    v_mfma_f32_16x16x32_bf16 v[96:99], a[16:19], a[164:167], v[96:99]
    s_waitcnt lgkmcnt(6)
    ds_read_b128 a[200:203], v180 offset:14336
    ds_read_b128 a[204:207], v180 offset:15360
    v_mfma_f32_16x16x32_bf16 v[96:99], a[32:35], a[168:171], v[96:99]
    ds_read_b128 a[208:211], v180 offset:12288
    v_mfma_f32_16x16x32_bf16 v[96:99], a[48:51], a[172:175], v[96:99]
    buffer_load_dwordx4 v248, s[20:23], s52 offen offset:2048 lds
    v_mfma_f32_16x16x32_bf16 v[116:119], a[52:55], a[172:175], v[116:119]
    ds_read_b128 a[212:215], v180 offset:13312
    ds_read_b128 a[216:219], v180 offset:16384
    v_mfma_f32_16x16x32_bf16 v[116:119], a[36:39], a[168:171], v[116:119]
    ds_read_b128 a[220:223], v180 offset:17408
    v_mfma_f32_16x16x32_bf16 v[116:119], a[20:23], a[164:167], v[116:119]
    ds_read_b128 a[224:227], v180 offset:8192
    v_mfma_f32_16x16x32_bf16 v[116:119], a[4:7], a[160:163], v[116:119]
    buffer_load_dwordx4 v249, s[20:23], s52 offen offset:3072 lds
    v_mfma_f32_16x16x32_bf16 v[136:139], a[8:11], a[160:163], v[136:139]
    s_add_u32 m0, s0, 0
    ds_read_b128 a[228:231], v180 offset:9216
    ds_read_b128 a[232:235], v180 offset:18432
    v_mfma_f32_16x16x32_bf16 v[136:139], a[24:27], a[164:167], v[136:139]
    s_waitcnt vmcnt(12)
    ds_read_b64_tr_b16 a[72:73], v233 offset:0
    v_mfma_f32_16x16x32_bf16 v[136:139], a[40:43], a[168:171], v[136:139]
    ds_read_b64_tr_b16 a[74:75], v233 offset:2048
    ds_read_b64_tr_b16 a[64:65], v231 offset:0
    v_mfma_f32_16x16x32_bf16 v[136:139], a[56:59], a[172:175], v[136:139]
    buffer_load_dwordx4 v254, s[24:27], s53 offen offset:0 sc1 lds
    v_mfma_f32_16x16x32_bf16 v[156:159], a[60:63], a[172:175], v[156:159]
    ds_read_b64_tr_b16 a[66:67], v231 offset:2048
    ds_read_b64_tr_b16 a[76:77], v234 offset:0
    v_mfma_f32_16x16x32_bf16 v[156:159], a[44:47], a[168:171], v[156:159]
    ds_read_b64_tr_b16 a[78:79], v234 offset:2048
    ds_read_b64_tr_b16 a[68:69], v232 offset:0
    v_mfma_f32_16x16x32_bf16 v[156:159], a[28:31], a[164:167], v[156:159]
    ds_read_b64_tr_b16 a[70:71], v232 offset:2048
    ds_read_b128 a[236:239], v180 offset:19456
    v_mfma_f32_16x16x32_bf16 v[156:159], a[12:15], a[160:163], v[156:159]
    s_waitcnt lgkmcnt(10)
    v_mfma_f32_16x16x32_bf16 v[160:163], a[12:15], a[176:179], v[160:163]
    buffer_load_dwordx4 v254, s[24:27], s53 offen offset:1024 sc1 lds
    v_mfma_f32_16x16x32_bf16 v[160:163], a[28:31], a[180:183], v[160:163]
    v_mfma_f32_16x16x32_bf16 v[160:163], a[44:47], a[184:187], v[160:163]
    v_mfma_f32_16x16x32_bf16 v[160:163], a[60:63], a[188:191], v[160:163]
    v_mfma_f32_16x16x32_bf16 v[140:143], a[56:59], a[188:191], v[140:143]
    buffer_load_dwordx4 v254, s[24:27], s53 offen offset:2048 sc1 lds
    v_mfma_f32_16x16x32_bf16 v[140:143], a[40:43], a[184:187], v[140:143]
    v_mfma_f32_16x16x32_bf16 v[140:143], a[24:27], a[180:183], v[140:143]
    s_waitcnt lgkmcnt(0)
    v_mfma_f32_16x16x32_bf16 v[140:143], a[8:11], a[176:179], v[140:143]
    v_mfma_f32_16x16x32_bf16 v[120:123], a[4:7], a[176:179], v[120:123]
    buffer_load_dwordx4 v254, s[24:27], s53 offen offset:3072 sc1 lds
    v_mfma_f32_16x16x32_bf16 v[120:123], a[20:23], a[180:183], v[120:123]
    s_add_u32 s53, s53, 4096
    v_mfma_f32_16x16x32_bf16 v[120:123], a[36:39], a[184:187], v[120:123]
    s_add_u32 m0, s0, 4096
    v_mfma_f32_16x16x32_bf16 v[120:123], a[52:55], a[188:191], v[120:123]
    s_waitcnt vmcnt(12)
    ds_read_b64_tr_b16 a[88:89], v233 offset:16384
    ds_read_b64_tr_b16 a[90:91], v233 offset:18432
    v_mfma_f32_16x16x32_bf16 v[100:103], a[48:51], a[188:191], v[100:103]
    buffer_load_dwordx4 v254, s[24:27], s53 offen offset:0 sc1 lds
    v_mfma_f32_16x16x32_bf16 v[100:103], a[32:35], a[184:187], v[100:103]
    ds_read_b64_tr_b16 a[80:81], v231 offset:16384
    ds_read_b64_tr_b16 a[82:83], v231 offset:18432
    v_mfma_f32_16x16x32_bf16 v[100:103], a[16:19], a[180:183], v[100:103]
    ds_read_b64_tr_b16 a[92:93], v234 offset:16384
    ds_read_b64_tr_b16 a[94:95], v234 offset:18432
    v_mfma_f32_16x16x32_bf16 v[100:103], a[0:3], a[176:179], v[100:103]
    ds_read_b64_tr_b16 a[84:85], v232 offset:16384
    ds_read_b64_tr_b16 a[86:87], v232 offset:18432
    v_mfma_f32_16x16x32_bf16 v[104:107], a[0:3], a[192:195], v[104:107]
    buffer_load_dwordx4 v254, s[24:27], s53 offen offset:1024 sc1 lds
    v_mfma_f32_16x16x32_bf16 v[104:107], a[16:19], a[196:199], v[104:107]
    v_mfma_f32_16x16x32_bf16 v[104:107], a[32:35], a[200:203], v[104:107]
    v_mfma_f32_16x16x32_bf16 v[104:107], a[48:51], a[204:207], v[104:107]
    v_mfma_f32_16x16x32_bf16 v[124:127], a[52:55], a[204:207], v[124:127]
    buffer_load_dwordx4 v254, s[24:27], s53 offen offset:2048 sc1 lds
    v_mfma_f32_16x16x32_bf16 v[124:127], a[36:39], a[200:203], v[124:127]
    v_mfma_f32_16x16x32_bf16 v[124:127], a[20:23], a[196:199], v[124:127]
    v_mfma_f32_16x16x32_bf16 v[124:127], a[4:7], a[192:195], v[124:127]
    v_mfma_f32_16x16x32_bf16 v[144:147], a[8:11], a[192:195], v[144:147]
    buffer_load_dwordx4 v254, s[24:27], s53 offen offset:3072 sc1 lds
    v_mfma_f32_16x16x32_bf16 v[144:147], a[24:27], a[196:199], v[144:147]
    s_add_u32 s53, s53, 4096
    v_mfma_f32_16x16x32_bf16 v[144:147], a[40:43], a[200:203], v[144:147]
    s_add_u32 m0, s0, 8192
    v_mfma_f32_16x16x32_bf16 v[144:147], a[56:59], a[204:207], v[144:147]
    s_waitcnt vmcnt(12)
    ds_read_b64_tr_b16 a[104:105], v178 offset:0
    ds_read_b64_tr_b16 a[106:107], v178 offset:2048
    v_mfma_f32_16x16x32_bf16 v[164:167], a[60:63], a[204:207], v[164:167]
    buffer_load_dwordx4 v254, s[24:27], s53 offen offset:0 sc1 lds
    v_mfma_f32_16x16x32_bf16 v[164:167], a[44:47], a[200:203], v[164:167]
    ds_read_b64_tr_b16 a[96:97], v176 offset:0
    ds_read_b64_tr_b16 a[98:99], v176 offset:2048
    v_mfma_f32_16x16x32_bf16 v[164:167], a[28:31], a[196:199], v[164:167]
    ds_read_b64_tr_b16 a[108:109], v179 offset:0
    ds_read_b64_tr_b16 a[110:111], v179 offset:2048
    v_mfma_f32_16x16x32_bf16 v[164:167], a[12:15], a[192:195], v[164:167]
    ds_read_b64_tr_b16 a[100:101], v177 offset:0
    ds_read_b64_tr_b16 a[102:103], v177 offset:2048
    v_mfma_f32_16x16x32_bf16 v[168:171], a[12:15], a[208:211], v[168:171]
    buffer_load_dwordx4 v254, s[24:27], s53 offen offset:1024 sc1 lds
    v_mfma_f32_16x16x32_bf16 v[168:171], a[28:31], a[212:215], v[168:171]
    s_add_u32 s53, s78, 3072
    v_mfma_f32_16x16x32_bf16 v[168:171], a[44:47], a[216:219], v[168:171]
    v_mfma_f32_16x16x32_bf16 v[168:171], a[60:63], a[220:223], v[168:171]
    v_mfma_f32_16x16x32_bf16 v[148:151], a[56:59], a[220:223], v[148:151]
    v_mfma_f32_16x16x32_bf16 v[148:151], a[40:43], a[216:219], v[148:151]
    v_mfma_f32_16x16x32_bf16 v[148:151], a[24:27], a[212:215], v[148:151]
    v_mfma_f32_16x16x32_bf16 v[148:151], a[8:11], a[208:211], v[148:151]
    v_mfma_f32_16x16x32_bf16 v[128:131], a[4:7], a[208:211], v[128:131]
    v_mfma_f32_16x16x32_bf16 v[128:131], a[20:23], a[212:215], v[128:131]
    s_waitcnt vmcnt(10)
    ds_read_b64_tr_b16 a[120:121], v178 offset:16896
    ds_read_b64_tr_b16 a[122:123], v178 offset:18944
    v_mfma_f32_16x16x32_bf16 v[128:131], a[36:39], a[216:219], v[128:131]
    ds_read_b64_tr_b16 a[112:113], v176 offset:16896
    ds_read_b64_tr_b16 a[114:115], v176 offset:18944
    v_mfma_f32_16x16x32_bf16 v[128:131], a[52:55], a[220:223], v[128:131]
    ds_read_b64_tr_b16 a[124:125], v179 offset:16896
    ds_read_b64_tr_b16 a[126:127], v179 offset:18944
    v_mfma_f32_16x16x32_bf16 v[108:111], a[48:51], a[220:223], v[108:111]
    ds_read_b64_tr_b16 a[116:117], v177 offset:16896
    ds_read_b64_tr_b16 a[118:119], v177 offset:18944
    v_mfma_f32_16x16x32_bf16 v[108:111], a[32:35], a[216:219], v[108:111]
    v_mfma_f32_16x16x32_bf16 v[108:111], a[16:19], a[212:215], v[108:111]
    v_mfma_f32_16x16x32_bf16 v[108:111], a[0:3], a[208:211], v[108:111]
    v_mfma_f32_16x16x32_bf16 v[112:115], a[0:3], a[224:227], v[112:115]
    v_mfma_f32_16x16x32_bf16 v[112:115], a[16:19], a[228:231], v[112:115]
    v_mfma_f32_16x16x32_bf16 v[112:115], a[32:35], a[232:235], v[112:115]
    v_mfma_f32_16x16x32_bf16 v[112:115], a[48:51], a[236:239], v[112:115]
    v_mfma_f32_16x16x32_bf16 v[132:135], a[52:55], a[236:239], v[132:135]
    v_mfma_f32_16x16x32_bf16 v[132:135], a[36:39], a[232:235], v[132:135]
    v_mfma_f32_16x16x32_bf16 v[132:135], a[20:23], a[228:231], v[132:135]
    v_mfma_f32_16x16x32_bf16 v[132:135], a[4:7], a[224:227], v[132:135]
    s_waitcnt vmcnt(6)
    s_barrier
    s_waitcnt vmcnt(2)
    v_mfma_f32_16x16x32_bf16 v[152:155], a[8:11], a[224:227], v[152:155]
    s_barrier
    ds_read_b128 a[240:243], v181 offset:4096
    ds_read_b128 a[244:247], v181 offset:5120
    v_mfma_f32_16x16x32_bf16 v[152:155], a[24:27], a[228:231], v[152:155]
    ds_read_b128 a[248:251], v181 offset:0
    v_mfma_f32_16x16x32_bf16 v[152:155], a[40:43], a[232:235], v[152:155]
    ds_read_b128 a[252:255], v181 offset:1024
    v_mfma_f32_16x16x32_bf16 v[152:155], a[56:59], a[236:239], v[152:155]
    ds_read_b128 a[128:131], v181 offset:3072
    v_mfma_f32_16x16x32_bf16 v[172:175], a[60:63], a[236:239], v[172:175]
    ds_read_b128 a[132:135], v181 offset:2048
    v_mfma_f32_16x16x32_bf16 v[172:175], a[44:47], a[232:235], v[172:175]
    ds_read_b128 a[136:139], v181 offset:7168
    v_mfma_f32_16x16x32_bf16 v[172:175], a[28:31], a[228:231], v[172:175]
    ds_read_b128 a[140:143], v181 offset:6144
    v_mfma_f32_16x16x32_bf16 v[172:175], a[12:15], a[224:227], v[172:175]
    s_waitcnt lgkmcnt(7)
    ds_read_b128 a[144:147], v182 offset:0
    v_mfma_f32_16x16x32_bf16 v[136:139], a[72:75], a[240:243], v[136:139]
    s_waitcnt lgkmcnt(7)
    ds_read_b128 a[148:151], v182 offset:1024
    v_mfma_f32_16x16x32_bf16 v[136:139], a[88:91], a[244:247], v[136:139]
    s_waitcnt lgkmcnt(7)
    ds_read_b128 a[152:155], v182 offset:4096
    v_mfma_f32_16x16x32_bf16 v[136:139], a[104:107], a[248:251], v[136:139]
    s_waitcnt lgkmcnt(7)
    ds_read_b128 a[156:159], v182 offset:5120
    v_mfma_f32_16x16x32_bf16 v[136:139], a[120:123], a[252:255], v[136:139]
    s_waitcnt lgkmcnt(7)
    ds_read_b128 a[160:163], v182 offset:7168
    v_mfma_f32_16x16x32_bf16 v[140:143], a[120:123], a[128:131], v[140:143]
    s_waitcnt lgkmcnt(7)
    ds_read_b128 a[164:167], v182 offset:6144
    v_mfma_f32_16x16x32_bf16 v[140:143], a[104:107], a[132:135], v[140:143]
    s_waitcnt lgkmcnt(7)
    ds_read_b128 a[168:171], v182 offset:3072
    v_mfma_f32_16x16x32_bf16 v[140:143], a[88:91], a[136:139], v[140:143]
    s_waitcnt lgkmcnt(7)
    s_waitcnt vmcnt(0)
    s_barrier
    v_mfma_f32_16x16x32_bf16 v[140:143], a[72:75], a[140:143], v[140:143]
    s_waitcnt lgkmcnt(5)
    ds_read_b128 a[172:175], v182 offset:2048
    ds_read_b128 a[176:179], v181 offset:8192
    v_mfma_f32_16x16x32_bf16 v[144:147], a[72:75], a[144:147], v[144:147]
    ds_read_b128 a[180:183], v181 offset:9216
    v_mfma_f32_16x16x32_bf16 v[144:147], a[88:91], a[148:151], v[144:147]
    s_waitcnt lgkmcnt(6)
    ds_read_b128 a[184:187], v182 offset:8192
    v_mfma_f32_16x16x32_bf16 v[144:147], a[104:107], a[152:155], v[144:147]
    ds_read_b128 a[188:191], v182 offset:9216
    v_mfma_f32_16x16x32_bf16 v[144:147], a[120:123], a[156:159], v[144:147]
    s_waitcnt lgkmcnt(6)
    ds_write_b128 v183, v[136:139] offset:0
    v_mfma_f32_16x16x32_bf16 v[148:151], a[120:123], a[160:163], v[148:151]
    v_mfma_f32_16x16x32_bf16 v[148:151], a[104:107], a[164:167], v[148:151]
    s_waitcnt lgkmcnt(5)
    v_mfma_f32_16x16x32_bf16 v[148:151], a[88:91], a[168:171], v[148:151]
    ds_write_b128 v183, v[140:143] offset:1024
    v_mfma_f32_16x16x32_bf16 v[148:151], a[72:75], a[172:175], v[148:151]
    s_waitcnt lgkmcnt(3)
    v_mfma_f32_16x16x32_bf16 v[152:155], a[72:75], a[176:179], v[152:155]
    ds_write_b128 v183, v[144:147] offset:2048
    v_mfma_f32_16x16x32_bf16 v[152:155], a[88:91], a[180:183], v[152:155]
    v_mfma_f32_16x16x32_bf16 v[152:155], a[104:107], a[184:187], v[152:155]
    s_waitcnt lgkmcnt(2)
    v_mfma_f32_16x16x32_bf16 v[152:155], a[120:123], a[188:191], v[152:155]
    v_mfma_f32_16x16x32_bf16 v[96:99], a[64:67], a[240:243], v[96:99]
    ds_write_b128 v183, v[148:151] offset:3072
    v_mfma_f32_16x16x32_bf16 v[96:99], a[80:83], a[244:247], v[96:99]
    v_mfma_f32_16x16x32_bf16 v[96:99], a[96:99], a[248:251], v[96:99]
    s_nop 2
    v_mfma_f32_16x16x32_bf16 v[96:99], a[112:115], a[252:255], v[96:99]
    ds_write_b128 v183, v[152:155] offset:4096
    v_mfma_f32_16x16x32_bf16 v[100:103], a[112:115], a[128:131], v[100:103]
    v_mfma_f32_16x16x32_bf16 v[100:103], a[96:99], a[132:135], v[100:103]
    v_mfma_f32_16x16x32_bf16 v[100:103], a[80:83], a[136:139], v[100:103]
    v_mfma_f32_16x16x32_bf16 v[100:103], a[64:67], a[140:143], v[100:103]
    v_mfma_f32_16x16x32_bf16 v[104:107], a[64:67], a[144:147], v[104:107]
    s_waitcnt lgkmcnt(0)
    v_mfma_f32_16x16x32_bf16 v[104:107], a[80:83], a[148:151], v[104:107]
    s_barrier
    ds_read_b128 v[4:7], v237 offset:0
    ds_read_b128 v[12:15], v237 offset:1024
    v_mfma_f32_16x16x32_bf16 v[104:107], a[96:99], a[152:155], v[104:107]
    ds_read_b128 v[20:23], v237 offset:2048
    v_mfma_f32_16x16x32_bf16 v[104:107], a[112:115], a[156:159], v[104:107]
    ds_read_b128 v[28:31], v237 offset:3072
    v_mfma_f32_16x16x32_bf16 v[108:111], a[112:115], a[160:163], v[108:111]
    ds_read_b128 v[36:39], v237 offset:4096
    v_mfma_f32_16x16x32_bf16 v[108:111], a[96:99], a[164:167], v[108:111]
    v_mfma_f32_16x16x32_bf16 v[108:111], a[80:83], a[168:171], v[108:111]
    v_mfma_f32_16x16x32_bf16 v[108:111], a[64:67], a[172:175], v[108:111]
    v_mfma_f32_16x16x32_bf16 v[112:115], a[64:67], a[176:179], v[112:115]
    s_waitcnt lgkmcnt(4)
    v_add_f32 v96, v96, v4
    v_add_f32 v97, v97, v5
    v_mfma_f32_16x16x32_bf16 v[112:115], a[80:83], a[180:183], v[112:115]
    s_waitcnt lgkmcnt(3)
    v_add_f32 v98, v98, v6
    v_add_f32 v99, v99, v7
    v_mfma_f32_16x16x32_bf16 v[112:115], a[96:99], a[184:187], v[112:115]
    s_waitcnt lgkmcnt(2)
    v_add_f32 v100, v100, v12
    v_add_f32 v101, v101, v13
    v_mfma_f32_16x16x32_bf16 v[112:115], a[112:115], a[188:191], v[112:115]
    s_waitcnt lgkmcnt(1)
    v_add_f32 v108, v108, v28
    v_add_f32 v109, v109, v29
    v_mfma_f32_16x16x32_bf16 v[156:159], a[76:79], a[240:243], v[156:159]
    s_waitcnt lgkmcnt(0)
    buffer_load_dword v230, v91, s[24:27], s74 offen offset:0 sc1
    v_mfma_f32_16x16x32_bf16 v[156:159], a[92:95], a[244:247], v[156:159]
    v_add_f32 v110, v110, v30
    v_add_f32 v111, v111, v31
    v_mfma_f32_16x16x32_bf16 v[156:159], a[108:111], a[248:251], v[156:159]
    v_add_f32 v102, v102, v14
    v_add_f32 v103, v103, v15
    v_mfma_f32_16x16x32_bf16 v[156:159], a[124:127], a[252:255], v[156:159]
    v_add_f32 v112, v112, v36
    v_add_f32 v113, v113, v37
    v_mfma_f32_16x16x32_bf16 v[160:163], a[124:127], a[128:131], v[160:163]
    v_add_f32 v114, v114, v38
    v_add_f32 v115, v115, v39
    v_mfma_f32_16x16x32_bf16 v[160:163], a[108:111], a[132:135], v[160:163]
    v_add_f32 v104, v104, v20
    v_add_f32 v105, v105, v21
    v_mfma_f32_16x16x32_bf16 v[160:163], a[92:95], a[136:139], v[160:163]
    v_add_f32 v106, v106, v22
    v_add_f32 v107, v107, v23
    v_mfma_f32_16x16x32_bf16 v[160:163], a[76:79], a[140:143], v[160:163]
    v_cvt_pk_bf16_f32 v0, v96, v97
    v_cvt_pk_bf16_f32 v1, v98, v99
    v_mfma_f32_16x16x32_bf16 v[164:167], a[76:79], a[144:147], v[164:167]
    v_cvt_pk_bf16_f32 v2, v108, v109
    v_cvt_pk_bf16_f32 v3, v110, v229
    v_mfma_f32_16x16x32_bf16 v[164:167], a[92:95], a[148:151], v[164:167]
    buffer_store_dwordx4 v[0:3], v89, s[24:27], s78 offen offset:0 sc1
    v_mfma_f32_16x16x32_bf16 v[164:167], a[108:111], a[152:155], v[164:167]
    v_cvt_pk_bf16_f32 v8, v100, v101
    v_cvt_pk_bf16_f32 v9, v102, v103
    v_mfma_f32_16x16x32_bf16 v[164:167], a[124:127], a[156:159], v[164:167]
    v_cvt_pk_bf16_f32 v10, v112, v113
    v_cvt_pk_bf16_f32 v11, v114, v229
    v_mfma_f32_16x16x32_bf16 v[168:171], a[124:127], a[160:163], v[168:171]
    buffer_store_dwordx4 v[8:11], v89, s[24:27], s78 offen offset:1024 sc1
    v_mfma_f32_16x16x32_bf16 v[168:171], a[108:111], a[164:167], v[168:171]
    v_cvt_pk_bf16_f32 v16, v104, v105
    v_cvt_pk_bf16_f32 v17, v106, v107
    v_mfma_f32_16x16x32_bf16 v[168:171], a[92:95], a[168:171], v[168:171]
    ds_write_b128 v183, v[156:159] offset:5120
    v_mfma_f32_16x16x32_bf16 v[168:171], a[76:79], a[172:175], v[168:171]
    v_cvt_pk_bf16_f32 v18, v111, v115
    v_mfma_f32_16x16x32_bf16 v[172:175], a[76:79], a[176:179], v[172:175]
    buffer_store_dwordx4 v[16:19], v89, s[24:27], s78 offen offset:2048 sc1
    v_mfma_f32_16x16x32_bf16 v[172:175], a[92:95], a[180:183], v[172:175]
    ds_write_b128 v183, v[160:163] offset:6144
    v_mfma_f32_16x16x32_bf16 v[172:175], a[108:111], a[184:187], v[172:175]
    v_mfma_f32_16x16x32_bf16 v[172:175], a[124:127], a[188:191], v[172:175]
    ds_write_b128 v183, v[164:167] offset:7168
    v_mfma_f32_16x16x32_bf16 v[116:119], a[68:71], a[240:243], v[116:119]
    buffer_store_dword v228, v90, s[24:27], s72 offen offset:0 sc1
    v_mfma_f32_16x16x32_bf16 v[116:119], a[84:87], a[244:247], v[116:119]
    ds_write_b128 v183, v[168:171] offset:8192
    v_mfma_f32_16x16x32_bf16 v[116:119], a[100:103], a[248:251], v[116:119]
    v_mfma_f32_16x16x32_bf16 v[116:119], a[116:119], a[252:255], v[116:119]
    v_mfma_f32_16x16x32_bf16 v[120:123], a[116:119], a[128:131], v[120:123]
    ds_write_b128 v183, v[172:175] offset:9216
    v_mfma_f32_16x16x32_bf16 v[120:123], a[100:103], a[132:135], v[120:123]
    v_mfma_f32_16x16x32_bf16 v[120:123], a[84:87], a[136:139], v[120:123]
    v_mfma_f32_16x16x32_bf16 v[120:123], a[68:71], a[140:143], v[120:123]
    v_mfma_f32_16x16x32_bf16 v[124:127], a[68:71], a[144:147], v[124:127]
    v_mfma_f32_16x16x32_bf16 v[124:127], a[84:87], a[148:151], v[124:127]
    v_mfma_f32_16x16x32_bf16 v[124:127], a[100:103], a[152:155], v[124:127]
    s_waitcnt lgkmcnt(0)
    v_mfma_f32_16x16x32_bf16 v[124:127], a[116:119], a[156:159], v[124:127]
    s_barrier
    ds_read_b128 v[44:47], v237 offset:5120
    ds_read_b128 v[52:55], v237 offset:6144
    v_mfma_f32_16x16x32_bf16 v[128:131], a[116:119], a[160:163], v[128:131]
    ds_read_b128 v[60:63], v237 offset:7168
    v_mfma_f32_16x16x32_bf16 v[128:131], a[100:103], a[164:167], v[128:131]
    ds_read_b128 v[68:71], v237 offset:8192
    ds_read_b128 v[76:79], v237 offset:9216
    v_mfma_f32_16x16x32_bf16 v[128:131], a[84:87], a[168:171], v[128:131]
    v_mfma_f32_16x16x32_bf16 v[128:131], a[68:71], a[172:175], v[128:131]
    v_mfma_f32_16x16x32_bf16 v[132:135], a[68:71], a[176:179], v[132:135]
    v_mfma_f32_16x16x32_bf16 v[132:135], a[84:87], a[180:183], v[132:135]
    v_mfma_f32_16x16x32_bf16 v[132:135], a[100:103], a[184:187], v[132:135]
    s_waitcnt lgkmcnt(4)
    v_add_f32 v116, v116, v44
    v_add_f32 v117, v117, v45
    v_mfma_f32_16x16x32_bf16 v[132:135], a[116:119], a[188:191], v[132:135]
    s_waitcnt lgkmcnt(3)
    v_add_f32 v118, v118, v46
    v_add_f32 v119, v119, v47
    v_add_f32 v120, v120, v52
    v_add_f32 v121, v121, v53
    v_add_f32 v122, v122, v54
    v_add_f32 v123, v123, v55
    s_waitcnt lgkmcnt(1)
    v_pk_add_f32 v[124:125], v[124:125], v[60:61]
    v_pk_add_f32 v[128:129], v[128:129], v[68:69]
    v_pk_add_f32 v[130:131], v[130:131], v[70:71]
    v_pk_add_f32 v[126:127], v[126:127], v[62:63]
    v_cvt_pk_bf16_f32 v24, v116, v117
    s_waitcnt lgkmcnt(0)
    v_pk_add_f32 v[132:133], v[132:133], v[76:77]
    v_pk_add_f32 v[134:135], v[134:135], v[78:79]
    v_cvt_pk_bf16_f32 v25, v118, v119
    v_cvt_pk_bf16_f32 v26, v128, v129
    v_cvt_pk_bf16_f32 v27, v130, v229
    buffer_store_dwordx4 v[24:27], v89, s[24:27], s53 offen offset:0 sc1
    v_cvt_pk_bf16_f32 v32, v120, v121
    v_cvt_pk_bf16_f32 v33, v122, v123
    v_cvt_pk_bf16_f32 v34, v132, v133
    v_cvt_pk_bf16_f32 v35, v134, v229
    buffer_store_dwordx4 v[32:35], v89, s[24:27], s53 offen offset:1024 sc1
    v_cvt_pk_bf16_f32 v40, v124, v125
    v_cvt_pk_bf16_f32 v41, v126, v127
    v_cvt_pk_bf16_f32 v42, v131, v135
    buffer_store_dwordx4 v[40:43], v89, s[24:27], s53 offen offset:2048 sc1
    v_and_b32 v121, 15, v255
    v_bfe_u32 v122, v255, 4, 1
    v_mul_u32_u24 v122, 48, v122
    v_add_u32 v121, v121, v122
    v_lshrrev_b32 v122, 5, v255
    v_lshlrev_b32 v122, 3, v122
    v_lshl_add_u32 v121, v121, 11, v122
    v_mul_f32 v120, 4.0, v229
    s_mov_b32 s46, 0
    v_add_u32 v123, 84480, v254
    s_cmp_eq_u32 s68, 0
    s_cbranch_scc1 L_notown
    ds_write_b128 v123, v[0:3] offset:0
    ds_write_b128 v123, v[8:11] offset:1024
    ds_write_b128 v123, v[16:19] offset:2048
    ds_write_b128 v123, v[24:27] offset:3072
    ds_write_b128 v123, v[32:35] offset:4096
    ds_write_b128 v123, v[40:43] offset:5120
    s_waitcnt lgkmcnt(0)
L_notown:
    s_and_b32 s65, s41, 3
    s_lshl_b32 s65, s65, 4
    s_mov_b64 s[34:35], 0xffff
    s_lshl_b64 s[34:35], s[34:35], s65
    s_barrier
    s_mov_b64 exec, s[34:35]
    ds_read_b128 a[0:3], v88 offset:0
    ds_read_b128 a[4:7], v88 offset:256
    ds_read_b128 a[8:11], v88 offset:1024
    ds_read_b128 a[12:15], v88 offset:1280
    ds_read_b128 a[16:19], v88 offset:2048
    ds_read_b128 a[20:23], v88 offset:2304
    s_waitcnt lgkmcnt(0)
    s_mov_b64 exec, -1
    s_waitcnt vmcnt(7)
    v_cmp_ne_u32 vcc, s45, v230
    s_cbranch_vccz L_hinted
L_hpoll:
    buffer_load_dword v230, v91, s[24:27], s74 offen sc1
    s_add_u32 s46, s46, 1
    s_waitcnt vmcnt(0)
    v_cmp_ne_u32 vcc, s45, v230
    s_cbranch_vccz L_hinted
    s_cmp_lt_u32 s46, 131072
    s_cbranch_scc1 L_hpoll
L_hinted:
    s_barrier
L_retry:
    s_not_b64 exec, s[34:35]
    buffer_load_dwordx4 a[0:3], v185, s[24:27], s43 offen offset:0 sc1
    buffer_load_dwordx4 a[4:7], v185, s[24:27], s43 offen offset:256 sc1
    buffer_load_dwordx4 a[8:11], v185, s[24:27], s43 offen offset:1024 sc1
    buffer_load_dwordx4 a[12:15], v185, s[24:27], s43 offen offset:1280 sc1
    buffer_load_dwordx4 a[16:19], v185, s[24:27], s43 offen offset:2048 sc1
    buffer_load_dwordx4 a[20:23], v185, s[24:27], s43 offen offset:2304 sc1
    s_mov_b64 exec, -1
    s_add_u32 s46, s46, 1
    s_waitcnt vmcnt(5)
    v_mfma_f32_16x16x32_bf16 v[96:99], v[80:83], a[0:3], 0
    s_waitcnt vmcnt(3)
    v_mfma_f32_16x16x32_bf16 v[100:103], v[80:83], a[8:11], 0
    s_waitcnt vmcnt(1)
    v_mfma_f32_16x16x32_bf16 v[104:107], v[80:83], a[16:19], 0
    v_mfma_f32_16x16x32_bf16 v[96:99], v[84:87], a[4:7], v[96:99]
    v_mfma_f32_16x16x32_bf16 v[100:103], v[84:87], a[12:15], v[100:103]
    s_waitcnt vmcnt(0)
    v_mfma_f32_16x16x32_bf16 v[104:107], v[84:87], a[20:23], v[104:107]
    s_nop 4
    v_cmp_neq_f32 s[56:57], v99, v120
    v_cmp_neq_f32 s[32:33], v103, v120
    s_nop 0
    v_cmp_neq_f32 vcc, v107, v120
    s_cmp_gt_u32 s46, 131072
    s_cbranch_scc1 L_ok
    s_or_b64 s[56:57], s[56:57], s[32:33]
    s_or_b64 s[56:57], s[56:57], vcc
    s_and_b64 s[56:57], s[56:57], s[54:55]
    s_cbranch_scc1 L_retry
L_ok:
    s_mov_b64 vcc, s[54:55]
    v_cndmask_b32 v99, v99, v104, vcc
    v_cndmask_b32 v103, v103, v105, vcc
    v_cvt_pk_bf16_f32 v96, v96, v97
    v_cvt_pk_bf16_f32 v97, v98, v99
    v_cvt_pk_bf16_f32 v100, v100, v101
    v_cvt_pk_bf16_f32 v101, v102, v103
    v_cvt_pk_bf16_f32 v104, v104, v105
    v_cvt_pk_bf16_f32 v105, v106, v107
    s_add_u32 s65, s44, 32768
    s_add_u32 s66, s44, 65536
    buffer_store_dwordx2 v[96:97], v121, s[28:31], s44 offen offset:0
    buffer_store_dwordx2 v[100:101], v121, s[28:31], s65 offen offset:0
    s_not_b64 exec, s[54:55]
    buffer_store_dwordx2 v[104:105], v121, s[28:31], s66 offen offset:0
L_end:
    s_endpgm
L_nonce:
    s_mov_b32 s46, 0
    s_lshl_b32 s66, s42, 2
L_nonce_l:
    buffer_load_dword v228, off, s[48:51], s66 sc1
    s_add_u32 s46, s46, 1
    s_waitcnt vmcnt(0)
    v_readfirstlane_b32 s45, v228
    s_cmp_gt_u32 s46, 131072
    s_cbranch_scc1 L_nonce_ok
    s_cmp_eq_u32 s45, 0
    s_cbranch_scc1 L_nonce_l
    s_nop 4
    s_branch L_nonce_ok
L_spin:
    s_mov_b32 s46, 0
L_spin_l:
    buffer_load_dword v230, v186, s[24:27], 0 offen offset:0 sc1
    s_add_u32 s46, s46, 1
    s_waitcnt vmcnt(0)
    v_cmp_ne_u32 vcc, s45, v230
    s_cbranch_vccz L_spin_ok
    s_cmp_lt_u32 s46, 24
    s_cbranch_scc1 L_spin_l
    buffer_store_dword v228, off, s[24:27], s47 sc1
L_spin_g:
    buffer_load_dword v230, v186, s[24:27], 0 offen offset:0 sc1
    s_waitcnt vmcnt(0)
    v_cmp_ne_u32 s[32:33], s45, v230
    buffer_load_dword v230, v184, s[24:27], 0 offen offset:0 sc1
    s_add_u32 s46, s46, 1
    s_waitcnt vmcnt(0)
    v_cmp_ne_u32 vcc, s45, v230
    s_nop 0
    s_and_b64 vcc, vcc, s[32:33]
    s_cbranch_scc0 L_spin_ok
    s_cmp_lt_u32 s46, 131072
    s_cbranch_scc1 L_spin_g
    s_branch L_spin_ok
L_fallback:
    s_waitcnt vmcnt(0) lgkmcnt(0)
    s_nop 15
    s_mov_b32 s79, -1
    v_mov_b32 v0, 0xff800000
    v_mov_b32 v1, 0xff800000
    v_mov_b32 v2, 0xff800000
    s_mov_b32 s46, 0
L_fb_loop:
    s_barrier
    s_mov_b32 m0, s73
    s_add_u32 s72, s40, s46
    buffer_load_dwordx4 v250, s[12:15], s72 offen offset:0 lds
    buffer_load_dwordx4 v251, s[12:15], s72 offen offset:1056 lds
    buffer_load_dwordx4 v252, s[12:15], s72 offen offset:2112 lds
    buffer_load_dwordx4 v253, s[12:15], s72 offen offset:3168 lds
    s_waitcnt vmcnt(0)
    s_barrier
    ds_read_b128 a[0:3], v244 offset:0
    ds_read_b128 a[4:7], v244 offset:64
    ds_read_b128 a[8:11], v244 offset:128
    ds_read_b128 a[12:15], v244 offset:192
    s_waitcnt lgkmcnt(3)
    v_mfma_f32_16x16x32_bf16 v[16:19], a[0:3], a[208:211], 0
    v_mfma_f32_16x16x32_bf16 v[20:23], a[0:3], a[224:227], 0
    v_mfma_f32_16x16x32_bf16 v[24:27], a[0:3], a[240:243], 0
    s_waitcnt lgkmcnt(2)
    v_mfma_f32_16x16x32_bf16 v[16:19], a[4:7], a[212:215], v[16:19]
    v_mfma_f32_16x16x32_bf16 v[20:23], a[4:7], a[228:231], v[20:23]
    v_mfma_f32_16x16x32_bf16 v[24:27], a[4:7], a[244:247], v[24:27]
    s_waitcnt lgkmcnt(1)
    v_mfma_f32_16x16x32_bf16 v[16:19], a[8:11], a[216:219], v[16:19]
    v_mfma_f32_16x16x32_bf16 v[20:23], a[8:11], a[232:235], v[20:23]
    v_mfma_f32_16x16x32_bf16 v[24:27], a[8:11], a[248:251], v[24:27]
    s_waitcnt lgkmcnt(0)
    v_mfma_f32_16x16x32_bf16 v[16:19], a[12:15], a[220:223], v[16:19]
    v_mfma_f32_16x16x32_bf16 v[20:23], a[12:15], a[236:239], v[20:23]
    v_mfma_f32_16x16x32_bf16 v[24:27], a[12:15], a[252:255], v[24:27]
    s_nop 5
    v_max3_f32 v0, v0, v16, v17
    v_max3_f32 v0, v0, v18, v19
    v_max3_f32 v1, v1, v20, v21
    v_max3_f32 v1, v1, v22, v23
    v_max3_f32 v2, v2, v24, v25
    v_max3_f32 v2, v2, v26, v27
    ds_read_b128 a[0:3], v244 offset:256
    ds_read_b128 a[4:7], v244 offset:320
    ds_read_b128 a[8:11], v244 offset:384
    ds_read_b128 a[12:15], v244 offset:448
    s_waitcnt lgkmcnt(3)
    v_mfma_f32_16x16x32_bf16 v[16:19], a[0:3], a[208:211], 0
    v_mfma_f32_16x16x32_bf16 v[20:23], a[0:3], a[224:227], 0
    v_mfma_f32_16x16x32_bf16 v[24:27], a[0:3], a[240:243], 0
    s_waitcnt lgkmcnt(2)
    v_mfma_f32_16x16x32_bf16 v[16:19], a[4:7], a[212:215], v[16:19]
    v_mfma_f32_16x16x32_bf16 v[20:23], a[4:7], a[228:231], v[20:23]
    v_mfma_f32_16x16x32_bf16 v[24:27], a[4:7], a[244:247], v[24:27]
    s_waitcnt lgkmcnt(1)
    v_mfma_f32_16x16x32_bf16 v[16:19], a[8:11], a[216:219], v[16:19]
    v_mfma_f32_16x16x32_bf16 v[20:23], a[8:11], a[232:235], v[20:23]
    v_mfma_f32_16x16x32_bf16 v[24:27], a[8:11], a[248:251], v[24:27]
    s_waitcnt lgkmcnt(0)
    v_mfma_f32_16x16x32_bf16 v[16:19], a[12:15], a[220:223], v[16:19]
    v_mfma_f32_16x16x32_bf16 v[20:23], a[12:15], a[236:239], v[20:23]
    v_mfma_f32_16x16x32_bf16 v[24:27], a[12:15], a[252:255], v[24:27]
    s_nop 5
    v_max3_f32 v0, v0, v16, v17
    v_max3_f32 v0, v0, v18, v19
    v_max3_f32 v1, v1, v20, v21
    v_max3_f32 v1, v1, v22, v23
    v_max3_f32 v2, v2, v24, v25
    v_max3_f32 v2, v2, v26, v27
    ds_read_b128 a[0:3], v245 offset:0
    ds_read_b128 a[4:7], v245 offset:64
    ds_read_b128 a[8:11], v245 offset:128
    ds_read_b128 a[12:15], v245 offset:192
    s_waitcnt lgkmcnt(3)
    v_mfma_f32_16x16x32_bf16 v[16:19], a[0:3], a[208:211], 0
    v_mfma_f32_16x16x32_bf16 v[20:23], a[0:3], a[224:227], 0
    v_mfma_f32_16x16x32_bf16 v[24:27], a[0:3], a[240:243], 0
    s_waitcnt lgkmcnt(2)
    v_mfma_f32_16x16x32_bf16 v[16:19], a[4:7], a[212:215], v[16:19]
    v_mfma_f32_16x16x32_bf16 v[20:23], a[4:7], a[228:231], v[20:23]
    v_mfma_f32_16x16x32_bf16 v[24:27], a[4:7], a[244:247], v[24:27]
    s_waitcnt lgkmcnt(1)
    v_mfma_f32_16x16x32_bf16 v[16:19], a[8:11], a[216:219], v[16:19]
    v_mfma_f32_16x16x32_bf16 v[20:23], a[8:11], a[232:235], v[20:23]
    v_mfma_f32_16x16x32_bf16 v[24:27], a[8:11], a[248:251], v[24:27]
    s_waitcnt lgkmcnt(0)
    v_mfma_f32_16x16x32_bf16 v[16:19], a[12:15], a[220:223], v[16:19]
    v_mfma_f32_16x16x32_bf16 v[20:23], a[12:15], a[236:239], v[20:23]
    v_mfma_f32_16x16x32_bf16 v[24:27], a[12:15], a[252:255], v[24:27]
    s_nop 5
    v_max3_f32 v0, v0, v16, v17
    v_max3_f32 v0, v0, v18, v19
    v_max3_f32 v1, v1, v20, v21
    v_max3_f32 v1, v1, v22, v23
    v_max3_f32 v2, v2, v24, v25
    v_max3_f32 v2, v2, v26, v27
    ds_read_b128 a[0:3], v245 offset:256
    ds_read_b128 a[4:7], v245 offset:320
    ds_read_b128 a[8:11], v245 offset:384
    ds_read_b128 a[12:15], v245 offset:448
    s_waitcnt lgkmcnt(3)
    v_mfma_f32_16x16x32_bf16 v[16:19], a[0:3], a[208:211], 0
    v_mfma_f32_16x16x32_bf16 v[20:23], a[0:3], a[224:227], 0
    v_mfma_f32_16x16x32_bf16 v[24:27], a[0:3], a[240:243], 0
    s_waitcnt lgkmcnt(2)
    v_mfma_f32_16x16x32_bf16 v[16:19], a[4:7], a[212:215], v[16:19]
    v_mfma_f32_16x16x32_bf16 v[20:23], a[4:7], a[228:231], v[20:23]
    v_mfma_f32_16x16x32_bf16 v[24:27], a[4:7], a[244:247], v[24:27]
    s_waitcnt lgkmcnt(1)
    v_mfma_f32_16x16x32_bf16 v[16:19], a[8:11], a[216:219], v[16:19]
    v_mfma_f32_16x16x32_bf16 v[20:23], a[8:11], a[232:235], v[20:23]
    v_mfma_f32_16x16x32_bf16 v[24:27], a[8:11], a[248:251], v[24:27]
    s_waitcnt lgkmcnt(0)
    v_mfma_f32_16x16x32_bf16 v[16:19], a[12:15], a[220:223], v[16:19]
    v_mfma_f32_16x16x32_bf16 v[20:23], a[12:15], a[236:239], v[20:23]
    v_mfma_f32_16x16x32_bf16 v[24:27], a[12:15], a[252:255], v[24:27]
    s_nop 5
    v_max3_f32 v0, v0, v16, v17
    v_max3_f32 v0, v0, v18, v19
    v_max3_f32 v1, v1, v20, v21
    v_max3_f32 v1, v1, v22, v23
    v_max3_f32 v2, v2, v24, v25
    v_max3_f32 v2, v2, v26, v27
    s_add_u32 s46, s46, 16384
    s_cmp_lt_u32 s46, 0x20000
    s_cbranch_scc1 L_fb_loop
    v_mov_b32 v3, v0
    s_nop 1
    v_permlane32_swap_b32 v0, v3
    v_max_f32 v0, v0, v3
    v_mov_b32 v3, v0
    s_nop 1
    v_permlane16_swap_b32 v0, v3
    v_max_f32 v0, v0, v3
    v_sub_f32 v200, 0, v0
    v_sub_f32 v201, 0, v0
    v_sub_f32 v202, 0, v0
    v_sub_f32 v203, 0, v0
    v_mov_b32 v3, v1
    s_nop 1
    v_permlane32_swap_b32 v1, v3
    v_max_f32 v1, v1, v3
    v_mov_b32 v3, v1
    s_nop 1
    v_permlane16_swap_b32 v1, v3
    v_max_f32 v1, v1, v3
    v_sub_f32 v204, 0, v1
    v_sub_f32 v205, 0, v1
    v_sub_f32 v206, 0, v1
    v_sub_f32 v207, 0, v1
    v_mov_b32 v3, v2
    s_nop 1
    v_permlane32_swap_b32 v2, v3
    v_max_f32 v2, v2, v3
    v_mov_b32 v3, v2
    s_nop 1
    v_permlane16_swap_b32 v2, v3
    v_max_f32 v2, v2, v3
    v_sub_f32 v208, 0, v2
    v_sub_f32 v209, 0, v2
    v_sub_f32 v210, 0, v2
    v_sub_f32 v211, 0, v2
    s_barrier
    s_branch L_restart
L_codeend:
.section .rodata,"a"
.p2align 6
.amdhsa_kernel concat_heads__gqa_block_cached__gqa_block_cached__near_ridge_kernel
  .amdhsa_next_free_vgpr 512
  .amdhsa_next_free_sgpr 102
  .amdhsa_accum_offset 256
  .amdhsa_group_segment_fixed_size 0
  .amdhsa_kernarg_size 104
  .amdhsa_user_sgpr_count 2
  .amdhsa_user_sgpr_kernarg_segment_ptr 1
  .amdhsa_system_sgpr_workgroup_id_x 1
.end_amdhsa_kernel
```
